```python
import torch

def _softmax(x, axis=-1):
    return torch.softmax(x, dim=axis)
def _gelu(x):
    return torch.nn.functional.gelu(x, approximate="tanh")
def _silu(x):
    return torch.nn.functional.silu(x)
def _sigmoid(x):
    return torch.sigmoid(x)
def _layernorm(x, axis=-1, eps=1e-5):
    m = x.mean(dim=axis, keepdim=True)
    v = x.var(dim=axis, keepdim=True, unbiased=False)
    return (x - m) / torch.sqrt(v + eps)
def _scatter_add(tgt, idx, src, axis=0):
    return tgt.clone().index_add_(axis, idx, src)
def _segment_sum(src, seg, n):
    out = torch.zeros((n,) + src.shape[1:], dtype=src.dtype)
    return out.index_add_(0, seg, src)
def _pad(x, pw):
    flat = tuple(v for pair in reversed(pw) for v in pair)
    return torch.nn.functional.pad(x, flat)

kernel_name = 'gated_mix__ssm_conv_s4__softmax_full_mha__prompt'

def setup_inputs():

    _w = (lambda a: (lambda t: t.to(torch.bfloat16) if t.is_floating_point() else t)(torch.as_tensor(a)))
    def _A_setup():
        B, L, D, N = 1, 2048, 512, 128
        A_re = -(lambda _x: torch.exp(torch.as_tensor(_x)))((lambda *s: torch.randn(*s, dtype=torch.bfloat16) * 6.4)(D, N))
        A_im = torch.pi * (lambda *s: torch.randn(*s, dtype=torch.bfloat16) * 0.1)(D, N)
        B_re = (lambda *s: torch.randn(*s, dtype=torch.bfloat16) * 0.2)(D, N)
        B_im = (lambda *s: torch.randn(*s, dtype=torch.bfloat16) * 0.2)(D, N)
        C_re = (lambda *s: torch.randn(*s, dtype=torch.bfloat16) * 0.2)(D, N)
        C_im = (lambda *s: torch.randn(*s, dtype=torch.bfloat16) * 0.2)(D, N)
        log_dt = (lambda *s: torch.randn(*s, dtype=torch.bfloat16) * 0.1)(D) * 0.5 - 4.0
        Dskip = (lambda *s: torch.randn(*s, dtype=torch.bfloat16) * 0.1)(D)
        return {
            "u": _w((lambda *s: torch.randn(*s, dtype=torch.bfloat16) * 0.05)(B, L, D)),
            "A_re": _w(A_re),
            "A_im": _w(A_im),
            "B_re": _w(B_re),
            "B_im": _w(B_im),
            "C_re": _w(C_re),
            "C_im": _w(C_im),
            "log_dt": _w(log_dt),
            "Dskip": _w(Dskip),
        }
    _A_in = _A_setup()

    def _B_setup():
        B, S, D = 1, 2048, 512
        return {
            "x": _w((lambda *s: torch.randn(*s, dtype=torch.bfloat16) * 0.05)(B, S, D)),
            "wqkv": _w((lambda *s: torch.randn(*s, dtype=torch.bfloat16) * 0.8)(D, 3 * D)),
            "wo": _w((lambda *s: torch.randn(*s, dtype=torch.bfloat16) * 0.05)(D, D)),
        }
    _B_in = _B_setup()

    return {
        "A_u": _A_in["u"],
        "A_A_re": _A_in["A_re"],
        "A_A_im": _A_in["A_im"],
        "A_B_re": _A_in["B_re"],
        "A_B_im": _A_in["B_im"],
        "A_C_re": _A_in["C_re"],
        "A_C_im": _A_in["C_im"],
        "A_log_dt": _A_in["log_dt"],
        "A_Dskip": _A_in["Dskip"],
        "B_x": _B_in["x"],
        "B_wqkv": _B_in["wqkv"],
        "B_wo": _B_in["wo"],
        "gate_w": _w((lambda *s: torch.randn(*s, dtype=torch.bfloat16) * 0.05)(512) * 16.0),
    }

def reference(A_u, A_A_re, A_A_im, A_B_re, A_B_im, A_C_re, A_C_im, A_log_dt, A_Dskip, B_x, B_wqkv, B_wo, gate_w):
    def _A_ref(u, A_re, A_im, B_re, B_im, C_re, C_im, log_dt, Dskip):
        Bsz, L, D = u.shape
        dt = torch.exp(log_dt)[:, None]
        A = A_re + 1j * A_im
        Bc = B_re + 1j * B_im
        Cc = C_re + 1j * C_im
        logdA = dt * A
        dB = dt * Bc
        l = (lambda x, dt: x.to(dt))(torch.arange(L), A_re.dtype)
        P = torch.exp(logdA[:, :, None] * l[None, None, :])
        K = torch.einsum("dn,dnl,dn->dl", Cc, P, dB).real
        L2 = 2 * L
        Kp = _pad(K, ((0, 0), (0, L)))
        up = (lambda x, *d: x.permute(*d))(u, 0, 2, 1)
        up = _pad(up, ((0, 0), (0, 0), (0, L)))
        Kf = (lambda x, axes=(-2,-1): torch.fft.rfft2(x.float(), dim=axes))(Kp[:, None, :], axes=(-2, -1))
        Uf = (lambda x, axes=(-2,-1): torch.fft.rfft2(x.float(), dim=axes))(up[:, :, None, :], axes=(-2, -1))
        Yf = Uf * Kf[None, :, :, :]
        y = (lambda x, s, axes=(-2,-1): torch.fft.irfft2(x, s=s, dim=axes).to(torch.bfloat16))(Yf, (1, L2), axes=(-2, -1))[:, :, 0, :L]
        y = (lambda x, *d: x.permute(*d))(y, 0, 2, 1) + u * Dskip[None, None, :]
        return y

    def _B_ref(x, wqkv, wo):
        B, S, D = x.shape
        H = 32; Dh = D // H
        qkv = (lambda x, *d: x.permute(*d))((x @ wqkv).reshape(B, S, 3, H, Dh), 2, 0, 3, 1, 4)
        q, k, v = qkv[0], qkv[1], qkv[2]
        scale = Dh ** -0.5
        scores = torch.einsum("bhqd,bhkd->bhqk", q, k) * scale
        p = _softmax(scores, axis=-1)
        o = torch.einsum("bhqk,bhkd->bhqd", p, v)
        return (lambda x, *d: x.permute(*d))(o, 0, 2, 1, 3).reshape(B, S, D) @ wo

    x = A_u
    g = _sigmoid((x * gate_w).sum(-1, keepdims=True))
    a = _A_ref(x, A_A_re, A_A_im, A_B_re, A_B_im, A_C_re, A_C_im, A_log_dt, A_Dskip)
    b = _B_ref(x, B_wqkv, B_wo)
    return g * a + (1 - g) * b
```

```asm
; @launch grid=(256,1,1) block=(960,1,1) lds=163840
.amdgcn_target "amdgcn-amd-amdhsa--gfx950"
.text
.globl gated_mix__ssm_conv_s4__softmax_full_mha__prompt_kernel
.p2align 8
.type gated_mix__ssm_conv_s4__softmax_full_mha__prompt_kernel,@function
gated_mix__ssm_conv_s4__softmax_full_mha__prompt_kernel:
F_start:
  s_load_dwordx16 s[72:87], s[0:1], 0
  s_load_dwordx16 s[40:55], s[0:1], 64
  v_lshrrev_b32 v2, 6, v0
  s_cmp_ge_u32 s2, 256
  v_readfirstlane_b32 s15, v2
  s_cbranch_scc1 F_done
  v_and_b32 v1, 63, v0
  s_sub_u32 s15, s15, 1
  s_cbranch_scc0 F_role
  s_cmp_lt_u32 s2, 40
  s_cbranch_scc0 F_pf1
  s_getpc_b64 s[30:31]
  s_lshr_b32 s32, s2, 3
  s_lshl_b32 s32, s32, 12
  v_lshl_add_u32 v2, v1, 6, s32
  global_load_dword v3, v2, s[30:31]
F_pf1:
  v_lshlrev_b32 v2, 4, v1
  v_mov_b32 v4, 0
  v_mov_b32 v5, 0
  v_mov_b32 v6, 0
  v_mov_b32 v7, 0
  s_mov_b32 exec_hi, 0xf
  ds_write_b128 v2, v[4:7]
  s_mov_b32 exec_hi, -1
  v_lshlrev_b32 v2, 7, v1
  s_lshl_b32 s33, s2, 13
  s_add_u32 s33, s33, 0xa06000
  v_add_u32 v2, s33, v2
  s_cmp_lt_u32 s2, 4
  s_waitcnt lgkmcnt(0)
  s_cbranch_scc0 F_pf2
  global_store_dwordx4 v2, v[4:7], s[54:55] sc1
  s_lshl_b32 s33, s2, 2
  v_mov_b32 v2, s33
  v_mov_b32 v8, 1
  s_mov_b64 exec, 1
  s_waitcnt vmcnt(0)
  global_store_dword v2, v8, s[52:53] sc1
F_pf2:
  s_mov_b64 exec, -1
  s_mov_b32 s15, 14
F_role:
  s_and_b32 s10, s2, 7
  s_lshr_b32 s11, s2, 3
  s_lshr_b32 s12, s10, 1
  s_lshl_b32 s12, s12, 3
  s_and_b32 s3, s11, 7
  s_add_u32 s12, s12, s3
  s_and_b32 s6, s10, 1
  s_lshr_b32 s7, s11, 3
  s_lshl2_add_u32 s13, s6, s7
  s_lshl1_add_u32 s14, s7, s6
  s_add_u32 s14, s14, s3
  s_and_b32 s14, s14, 7
  s_xor_b32 s10, s10, 1
  s_cmp_lt_u32 s15, 8
  s_cbranch_scc0 F_notkgen
  s_and_b32 s16, s15, 1
  s_lshl1_add_u32 s17, s2, s16
  s_lshl_b32 s18, s17, 8
  v_lshl_add_u32 v2, v1, 2, s18
  s_lshl_b32 s18, s17, 1
  v_mov_b32 v3, s18
  s_waitcnt lgkmcnt(0)
  global_load_ushort v10, v3, s[86:87]
  global_load_dword v4, v2, s[74:75]
  global_load_dword v5, v2, s[76:77]
  s_cmp_lt_u32 s15, 4
  s_cbranch_scc1 F_notloader
  global_load_dword v6, v2, s[78:79]
  global_load_dword v7, v2, s[80:81]
  global_load_dword v8, v2, s[82:83]
  global_load_dword v9, v2, s[84:85]
  global_load_ushort v11, v3, s[40:41]
  s_branch F_notloader
F_notkgen:
  s_bitcmp1_b32 0xf00, s15
  s_cbranch_scc1 F_side
  s_cmp_eq_u32 s15, 14
  s_cbranch_scc1 F_nl2
  v_and_b32 v2, 15, v1
  v_and_b32 v3, 48, v1
  v_lshl_add_u32 v2, v2, 6, v3
  s_waitcnt lgkmcnt(0)
  global_load_dwordx4 v[64:67], v2, s[48:49]
  s_branch F_notloader
F_side:
  s_sub_u32 s15, s15, 8
  v_lshrrev_b32 v2, 3, v1
  v_bfe_u32 v3, v1, 4, 1
  v_and_b32 v6, 7, v1
  s_and_b32 s30, s15, 1
  s_lshl_b32 s30, s30, 2
  v_xor_b32 v7, v6, v3
  v_xor_b32 v7, s30, v7
  v_lshlrev_b32 v7, 4, v7
  v_lshl_add_u32 v4, v2, 10, v7
  v_xor_b32 v5, 32, v4
  v_lshlrev_b32 v3, 1, v3
  v_xor_b32 v7, v6, v3
  v_mul_u32_u24 v6, 3072, v2
  v_lshl_add_u32 v6, v7, 4, v6
  v_xor_b32 v7, 64, v6
  s_lshl_b32 s30, s12, 16
  s_lshl_b32 s31, s15, 14
  s_add_u32 s30, s30, s31
  s_mul_i32 s31, s15, 49152
  s_lshl_b32 s32, s13, 7
  s_add_u32 s31, s31, s32
  s_lshl_b32 s32, s15, 11
  s_add_u32 s32, s32, 32768
  s_mov_b32 s33, 0
  s_lshl_b32 s39, s15, 2
  s_add_u32 s39, s39, 576
  v_and_b32 v9, 7, v1
  v_mov_b32 v8, 0
  v_lshl_add_u32 v9, v9, 4, s39
  ds_write_b32 v9, v8
  s_waitcnt lgkmcnt(0)
  s_mov_b32 s16, s72
  s_mov_b32 s17, s73
  s_mov_b32 s18, 0x200000
  s_mov_b32 s19, 0x20000
  s_mov_b32 s20, s44
  s_mov_b32 s21, s45
  s_mov_b32 s22, 0x180000
  s_mov_b32 s23, 0x20000
  s_setprio 3
  s_getpc_b64 s[28:29]
F_ld:
  s_bitcmp1_b32 0xa8, s33
  s_cbranch_scc0 F_ld1
  s_barrier
F_ld1:
  s_add_u32 s34, s14, s33
  s_and_b32 s34, s34, 7
  s_lshl_b32 s35, s34, 7
  s_add_u32 s35, s35, s30
  s_mul_i32 s36, s34, 196608
  s_add_u32 s36, s36, s31
  s_and_b32 s37, s33, 3
  s_lshl_b32 s37, s37, 15
  s_add_u32 m0, s37, s32
  s_add_u32 s38, s35, 7168
  buffer_load_dwordx4 v4, s[16:19], s35 offen lds
  buffer_load_dwordx4 v5, s[16:19], s38 offen offset:1024 lds
  s_cmp_eq_u32 s33, 1
  s_cbranch_scc0 F_ldk
  s_barrier
F_ldk:
  s_add_u32 m0, m0, 8192
  s_add_u32 s38, s36, 23552
  buffer_load_dwordx4 v6, s[20:23], s36 offen lds
  buffer_load_dwordx4 v7, s[20:23], s38 offen offset:1024 lds
  s_add_u32 s36, s36, 1024
  s_add_u32 m0, m0, 8192
  s_add_u32 s38, s36, 23552
  buffer_load_dwordx4 v6, s[20:23], s36 offen lds
  buffer_load_dwordx4 v7, s[20:23], s38 offen offset:1024 lds
  s_add_u32 s36, s36, 1024
  s_add_u32 m0, m0, 8192
  s_add_u32 s38, s36, 23552
  buffer_load_dwordx4 v6, s[20:23], s36 offen lds
  buffer_load_dwordx4 v7, s[20:23], s38 offen offset:1024 lds
  s_mov_b32 m0, s39
  s_mov_b64 exec, 1
  global_load_lds_dword v8, s[28:29]
  s_mov_b64 exec, -1
  s_add_u32 s39, s39, 16
  s_add_u32 s33, s33, 1
  s_cmp_lt_u32 s33, 8
  s_cbranch_scc1 F_ld
  s_mov_b32 s8, s54
  s_mov_b32 s9, s55
  s_mov_b32 s24, s54
  s_mov_b32 s25, s55
  s_mov_b32 s26, 0xc00000
  s_mov_b32 s27, 0x20000
  s_barrier
  v_lshlrev_b32 v3, 4, v1
  s_mov_b32 s16, s52
  s_mov_b32 s17, s53
  s_mov_b32 s18, 0x100
  s_mov_b32 s19, 0x20000
  v_mov_b32 v8, 0
  v_mov_b32 v9, 1
  s_lshl_b32 s29, s15, 2
  s_and_b32 s30, s15, 1
  s_lshr_b32 s31, s15, 1
  v_and_b32 v2, 31, v1
  v_lshrrev_b32 v12, 5, v1
  v_lshlrev_b32 v113, 15, v12
  v_lshl_add_u32 v113, v2, 3, v113
  v_lshlrev_b32 v114, 10, v12
  v_lshl_add_u32 v114, v2, 2, v114
  s_lshl_b32 s36, s30, 7
  v_lshl_add_u32 v115, v2, 2, s36
  v_lshrrev_b32 v4, 3, v1
  v_lshlrev_b32 v4, 10, v4
  v_and_b32 v5, 7, v1
  v_bfe_u32 v6, v1, 4, 1
  v_lshlrev_b32 v6, 2, v6
  v_xor_b32 v5, v5, v6
  v_lshl_add_u32 v112, v5, 4, v4
  v_bfe_u32 v13, v1, 2, 2
  v_lshl_add_u32 v14, v12, 2, v13
  v_lshlrev_b32 v14, 7, v14
  v_lshrrev_b32 v13, 1, v13
  v_xor_b32 v13, s31, v13
  v_lshl_add_u32 v14, v13, 6, v14
  v_and_b32 v13, 16, v1
  v_lshl_add_u32 v14, v13, 1, v14
  v_and_b32 v13, 1, v1
  v_lshl_add_u32 v14, v13, 4, v14
  v_and_b32 v13, 2, v1
  v_lshl_add_u32 v14, v13, 2, v14
  s_lshl_b32 s36, s31, 15
  s_add_u32 s36, s36, 1024
  v_add_u32 v5, s36, v14
  v_xor_b32 v4, 64, v5
  v_and_b32 v6, 28, v1
  v_add_lshl_u32 v6, v6, v12, 10
  v_lshl_add_u32 v6, v13, 3, v6
  v_and_b32 v13, 1, v1
  v_lshl_add_u32 v6, v13, 5, v6
  s_lshl_b32 s36, s15, 12
  s_add_u32 s36, s36, 98304
  v_add_u32 v7, s36, v3
  v_xor_b32 v0, 0x2000, v7
  v_mov_b32 v80, 0
  v_mov_b32 v81, 0
  v_mov_b32 v82, 0
  v_mov_b32 v83, 0
  v_mov_b32 v84, 0
  v_mov_b32 v85, 0
  v_mov_b32 v86, 0
  v_mov_b32 v87, 0
  v_mov_b32 v88, 0
  v_mov_b32 v89, 0
  v_mov_b32 v90, 0
  v_mov_b32 v91, 0
  v_mov_b32 v92, 0
  v_mov_b32 v93, 0
  v_mov_b32 v94, 0
  v_mov_b32 v95, 0
  v_mov_b32 v96, 0
  v_mov_b32 v97, 0
  v_mov_b32 v98, 0
  v_mov_b32 v99, 0
  v_mov_b32 v100, 0
  v_mov_b32 v101, 0
  v_mov_b32 v102, 0
  v_mov_b32 v103, 0
  v_mov_b32 v104, 0
  v_mov_b32 v105, 0
  v_mov_b32 v106, 0
  v_mov_b32 v107, 0
  v_mov_b32 v108, 0
  v_mov_b32 v109, 0
  v_mov_b32 v110, 0
  v_mov_b32 v111, 0
  s_and_b32 s31, s11, 3
  s_lshl2_add_u32 s31, s10, s31
  s_lshr_b32 s28, s11, 2
  s_lshl3_add_u32 s30, s31, s28
  s_lshl_b32 s30, s30, 7
  s_add_u32 s30, s30, 0xa06004
  s_lshl_b32 s20, s15, 3
  s_lshl_b32 s37, s31, 11
  s_lshl2_add_u32 s32, s28, s15
  s_lshl_b32 s32, s32, 16
  s_add_u32 s37, s37, s32
  s_lshl_b32 s31, s31, 12
  s_add_u32 s31, s31, 0x202000
  s_lshl_b32 s32, s15, 11
  s_add_u32 s37, s37, 0x1000
  s_add_u32 s38, s32, 19200
  s_lshl_b32 s32, s15, 17
  s_add_u32 s31, s31, s32
  s_mul_i32 s33, s15, 2080
  s_add_u32 s33, s33, 27392
  v_and_b32 v10, 1, v1
  v_cmp_eq_u32 vcc, 0, v10
  v_bfe_u32 v11, v1, 1, 4
  v_mov_b32 v16, 0x3f803f80
  v_cndmask_b32 v16, 0, v16, vcc
  v_mul_u32_u24 v11, 8320, v11
  v_lshl_add_u32 v11, v10, 4, v11
  v_add_u32 v11, s33, v11
  v_mov_b32 v17, v16
  v_mov_b32 v18, v16
  v_mov_b32 v19, v16
  s_mov_b32 s35, 0
LW1:
  ds_read_b32 v10, v8 offset:96
  s_waitcnt lgkmcnt(0)
  v_readfirstlane_b32 s34, v10
  s_add_u32 s35, s35, 1
  s_cmp_ge_u32 s34, 6
  s_cbranch_scc1 LD2
  s_sleep 1
  s_cmp_lt_u32 s35, 0x186a00
  s_cbranch_scc1 LW1
LD2:
  ds_write_b128 v11, v[16:19] offset:2048
  s_waitcnt lgkmcnt(0)
  s_mov_b32 s36, 0xff
  s_mov_b32 s39, 0
  s_mul_i32 s33, s15, 4160
  s_add_u32 s33, s33, 27392
  s_mov_b32 s43, 66560
  s_cmp_eq_u32 s15, 0
  s_cbranch_scc0 F_f1w
  s_lshl_b32 s41, 0x01010101, s28
  s_mov_b32 s34, 0
  s_mov_b64 exec, 1
  v_mov_b32 v20, 0
  buffer_atomic_or v20, v8, s[24:27], s30 offen sc0 sc1
  s_sleep 4
  v_mov_b32 v21, 0
  buffer_atomic_or v21, v8, s[24:27], s30 offen sc0 sc1
  s_sleep 4
KW3:
  v_mov_b32 v22, 0
  buffer_atomic_or v22, v8, s[24:27], s30 offen sc0 sc1
  s_waitcnt vmcnt(2)
  v_readfirstlane_b32 s35, v20
  s_nop 0
  s_andn2_b32 s42, s41, s35
  s_cbranch_scc0 KD4
  v_mov_b32 v20, 0
  buffer_atomic_or v20, v8, s[24:27], s30 offen sc0 sc1
  s_waitcnt vmcnt(2)
  v_readfirstlane_b32 s35, v21
  s_nop 0
  s_andn2_b32 s42, s41, s35
  s_cbranch_scc0 KD4
  v_mov_b32 v21, 0
  buffer_atomic_or v21, v8, s[24:27], s30 offen sc0 sc1
  s_waitcnt vmcnt(2)
  v_readfirstlane_b32 s35, v22
  s_nop 0
  s_andn2_b32 s42, s41, s35
  s_cbranch_scc0 KD4
  s_add_u32 s34, s34, 1
  s_cmp_lt_u32 s34, 0x30d40
  s_cbranch_scc1 KW3
  s_mov_b32 s35, -1
KD4:
  s_mov_b64 exec, -1
  v_mov_b32 v10, s35
  ds_write_b32 v8, v10 offset:48
  s_branch F_f1d
F_f1w:
  s_mov_b32 s34, 0
LW5:
  ds_read_b32 v10, v8 offset:48
  s_waitcnt lgkmcnt(0)
  v_readfirstlane_b32 s35, v10
  s_add_u32 s34, s34, 1
  s_cmp_ge_u32 s35, 1
  s_cbranch_scc1 LD6
  s_sleep 1
  s_cmp_lt_u32 s34, 0x186a00
  s_cbranch_scc1 LW5
LD6:
  s_lshr_b32 s35, s35, s20
F_f1d:
  s_mov_b32 m0, s38
  s_mov_b32 s34, 0
  buffer_load_dwordx4 v3, s[24:27], s37 offen sc1 lds
  buffer_load_dwordx4 v3, s[24:27], s37 offen offset:1024 sc1 lds
  s_and_b32 s35, s35, s36
  s_cbranch_scc1 F_kv1
F_kv:
  s_mov_b64 exec, 1
  v_mov_b32 v10, 0
  buffer_atomic_or v10, v8, s[24:27], s30 offen sc0 sc1
  s_waitcnt vmcnt(0)
  v_readfirstlane_b32 s35, v10
  s_mov_b64 exec, -1
  s_add_u32 s34, s34, 1
  s_lshr_b32 s35, s35, s20
  s_cmp_lt_u32 s34, 0x30d40
  s_cselect_b32 s35, s35, -1
  s_and_b32 s35, s35, s36
  s_cbranch_scc1 F_kv1
  s_sleep 1
  s_branch F_kv
F_kv1:
  s_ff1_i32_b32 s40, s35
F_kv2:
  s_lshl_b32 s41, s40, 19
  s_mov_b32 m0, s33
  s_add_u32 s41, s41, s31
  buffer_load_dwordx4 v3, s[24:27], s41 offen sc1 lds
  buffer_load_dwordx4 v3, s[24:27], s41 offen offset:1024 sc1 lds
  s_add_u32 m0, s33, 32
  s_bitset0_b32 s35, s40
  buffer_load_dwordx4 v3, s[24:27], s41 offen offset:2048 sc1 lds
  buffer_load_dwordx4 v3, s[24:27], s41 offen offset:3072 sc1 lds
  s_bitset0_b32 s36, s40
  s_bitcmp1_b32 s39, 0
  s_cselect_b32 s42, 0xffff3d00, s43
  s_add_u32 s33, s33, s42
  s_bitcmp1_b32 0xa3, s39
  s_cbranch_scc0 F_kv3
  s_add_u32 m0, s29, 384
  s_mov_b64 exec, 1
  buffer_load_dword v8, s[16:19], 0 offen sc1 lds
  s_mov_b64 exec, -1
  s_add_u32 s29, s29, 16
F_kv3:
  s_add_u32 s39, s39, 1
F_kv4:
  s_cmp_lg_u32 s35, 0
  s_cbranch_scc1 F_kv1
  s_cmp_lg_u32 s36, 0
  s_cbranch_scc1 F_kv
  s_and_b32 s30, s15, 1
  s_lshr_b32 s31, s15, 1
  s_lshl_b32 s32, s12, 6
  s_lshl_b32 s33, s30, 5
  s_add_u32 s32, s32, s33
  s_lshl_b32 s33, s13, 6
  s_lshl_b32 s34, s31, 5
  s_add_u32 s33, s33, s34
  s_lshl_b32 s34, s33, 12
  s_lshr_b32 s35, s12, 2
  s_lshl1_add_u32 s35, s35, s30
  s_lshl_b32 s35, s35, 8
  s_add_u32 s34, s34, s35
  s_and_b32 s35, s12, 3
  s_lshl1_add_u32 s34, s35, s34
  s_add_u32 s34, s34, 0x805000
  s_mov_b32 s16, s46
  s_mov_b32 s17, s47
  s_mov_b32 s18, 0x80000
  s_mov_b32 s19, 0x20000
  s_mov_b32 s20, s50
  s_mov_b32 s21, s51
  s_mov_b32 s22, 0x200000
  s_mov_b32 s23, 0x20000
  s_lshl_b32 s36, s15, 17
  s_lshl_b32 s37, s13, 7
  s_add_u32 s36, s36, s37
  s_lshl_b32 s37, s15, 14
  s_add_u32 s37, s37, 1024
  s_mov_b32 s39, 0
LW7:
  ds_read_b32 v11, v8 offset:20
  s_waitcnt lgkmcnt(0)
  v_readfirstlane_b32 s38, v11
  s_add_u32 s39, s39, 1
  s_cmp_ge_u32 s38, 4
  s_cbranch_scc1 LD8
  s_sleep 32
  s_cmp_lt_u32 s39, 0x186a00
  s_cbranch_scc1 LW7
LD8:
  s_mov_b32 s39, 0
LW9:
  ds_read_b32 v11, v8 offset:16
  s_waitcnt lgkmcnt(0)
  v_readfirstlane_b32 s38, v11
  s_add_u32 s39, s39, 1
  s_cmp_ge_u32 s38, 2
  s_cbranch_scc1 LD10
  s_sleep 8
  s_cmp_lt_u32 s39, 0x186a00
  s_cbranch_scc1 LW9
LD10:
  s_mov_b32 s39, 0
LW11:
  ds_read_b32 v11, v8 offset:56
  s_waitcnt lgkmcnt(0)
  v_readfirstlane_b32 s38, v11
  s_add_u32 s39, s39, 1
  s_cmp_ge_u32 s38, 4
  s_cbranch_scc1 LD12
  s_sleep 16
  s_cmp_lt_u32 s39, 0x186a00
  s_cbranch_scc1 LW11
LD12:
  s_cmp_eq_u32 s15, 0
  s_cbranch_scc0 F_nf2
  s_lshr_b32 s38, s2, 5
  s_lshl_b32 s38, s38, 7
  s_add_u32 s38, s38, 0xa06008
  v_lshlrev_b32 v12, 10, v1
  v_lshlrev_b32 v13, s2, v9
  s_mov_b32 exec_hi, 0
  buffer_atomic_or v13, v12, s[24:27], s38 offen sc1
  s_mov_b64 exec, -1
F_nf2:
  s_mov_b32 s38, 16
F_wo:
  s_mov_b32 m0, s37
  s_add_u32 s37, s37, 1024
  buffer_load_dwordx4 v112, s[16:19], s36 offen lds
  s_add_u32 s36, s36, 8192
  s_sub_u32 s38, s38, 1
  s_cmp_lg_u32 s38, 0
  s_cbranch_scc1 F_wo
  s_lshl3_add_u32 s28, s12, s13
  s_lshl_b32 s28, s28, 7
  s_add_u32 s28, s28, 0xa06008
  s_mov_b32 s38, 0
KW13:
  s_mov_b64 exec, 1
  v_mov_b32 v11, 0
  buffer_atomic_or v11, v8, s[24:27], s28 offen sc0 sc1
  s_waitcnt vmcnt(0)
  v_readfirstlane_b32 s36, v11
  s_mov_b64 exec, -1
  s_andn2_b32 s37, -1, s36
  s_cbranch_scc0 KD14
  s_sleep 16
  s_add_u32 s38, s38, 1
  s_cmp_lt_u32 s38, 0x30d40
  s_cbranch_scc1 KW13
  s_mov_b32 s36, -1
KD14:
  s_add_u32 s28, s28, 4
  s_add_u32 s36, s34, 0
  buffer_load_short_d16_hi v80, v113, s[24:27], s36 offen sc1
  s_add_u32 s36, s34, 4096
  buffer_load_short_d16_hi v81, v113, s[24:27], s36 offen sc1
  s_add_u32 s36, s34, 8192
  buffer_load_short_d16_hi v82, v113, s[24:27], s36 offen sc1
  s_add_u32 s36, s34, 12288
  buffer_load_short_d16_hi v83, v113, s[24:27], s36 offen sc1
  s_add_u32 s36, s34, 16384
  buffer_load_short_d16_hi v84, v113, s[24:27], s36 offen sc1
  s_add_u32 s36, s34, 20480
  buffer_load_short_d16_hi v85, v113, s[24:27], s36 offen sc1
  s_add_u32 s36, s34, 24576
  buffer_load_short_d16_hi v86, v113, s[24:27], s36 offen sc1
  s_add_u32 s36, s34, 28672
  buffer_load_short_d16_hi v87, v113, s[24:27], s36 offen sc1
  s_add_u32 s36, s34, 65536
  buffer_load_short_d16_hi v88, v113, s[24:27], s36 offen sc1
  s_add_u32 s36, s34, 69632
  buffer_load_short_d16_hi v89, v113, s[24:27], s36 offen sc1
  s_add_u32 s36, s34, 73728
  buffer_load_short_d16_hi v90, v113, s[24:27], s36 offen sc1
  s_add_u32 s36, s34, 77824
  buffer_load_short_d16_hi v91, v113, s[24:27], s36 offen sc1
  s_add_u32 s36, s34, 81920
  buffer_load_short_d16_hi v92, v113, s[24:27], s36 offen sc1
  s_add_u32 s36, s34, 86016
  buffer_load_short_d16_hi v93, v113, s[24:27], s36 offen sc1
  s_add_u32 s36, s34, 90112
  buffer_load_short_d16_hi v94, v113, s[24:27], s36 offen sc1
  s_add_u32 s36, s34, 94208
  buffer_load_short_d16_hi v95, v113, s[24:27], s36 offen sc1
  s_and_b32 s36, s32, 255
  s_cbranch_scc1 F_nc
  s_lshr_b32 s36, s32, 4
  s_cbranch_scc0 F_nc
  s_lshl_b32 s37, s33, 7
  s_add_u32 s36, s36, s37
  s_add_u32 s36, s36, 0xb15ff0
  s_mov_b32 exec_lo, 7
  s_mov_b32 exec_hi, 7
  buffer_load_dword v96, v114, s[24:27], s36 offen offset:0 sc1
  buffer_load_dword v97, v114, s[24:27], s36 offen offset:128 sc1
  buffer_load_dword v98, v114, s[24:27], s36 offen offset:256 sc1
  buffer_load_dword v99, v114, s[24:27], s36 offen offset:384 sc1
  buffer_load_dword v100, v114, s[24:27], s36 offen offset:512 sc1
  buffer_load_dword v101, v114, s[24:27], s36 offen offset:640 sc1
  buffer_load_dword v102, v114, s[24:27], s36 offen offset:768 sc1
  buffer_load_dword v103, v114, s[24:27], s36 offen offset:896 sc1
  buffer_load_dword v104, v114, s[24:27], s36 offen offset:2048 sc1
  buffer_load_dword v105, v114, s[24:27], s36 offen offset:2176 sc1
  buffer_load_dword v106, v114, s[24:27], s36 offen offset:2304 sc1
  buffer_load_dword v107, v114, s[24:27], s36 offen offset:2432 sc1
  buffer_load_dword v108, v114, s[24:27], s36 offen offset:2560 sc1
  buffer_load_dword v109, v114, s[24:27], s36 offen offset:2688 sc1
  buffer_load_dword v110, v114, s[24:27], s36 offen offset:2816 sc1
  buffer_load_dword v111, v114, s[24:27], s36 offen offset:2944 sc1
  s_mov_b64 exec, -1
F_nc:
  ds_read_b32 v11, v115 offset:128
  s_mov_b32 s40, 0x55555555
  s_mov_b32 s41, s40
  s_mov_b32 s42, 0x33333333
  s_mov_b32 s43, s42
  s_lshl_b32 s32, s32, 10
  s_lshl_b32 s33, s33, 1
  s_add_u32 s32, s32, s33
  s_lshl1_add_u32 s34, s12, s31
  s_lshl_b32 s34, s34, 15
  s_lshl_b32 s35, s30, 10
  s_add_u32 s34, s34, s35
  s_add_u32 s34, s34, 0x1000
  s_lshl_b32 s35, s31, 4
  s_lshl_b32 s35, 0xffff, s35
  s_waitcnt vmcnt(0) lgkmcnt(0)
  s_barrier
  s_mov_b32 s38, 0
  s_mov_b64 exec, 1
  v_mov_b32 v13, 0
  buffer_atomic_or v13, v8, s[24:27], s28 offen sc0 sc1
  s_mov_b64 exec, -1
  ds_read_b64_tr_b16 v[56:57], v4 offset:0
  ds_read_b64_tr_b16 v[58:59], v4 offset:1024
  ds_read_b64_tr_b16 v[60:61], v5 offset:0
  ds_read_b64_tr_b16 v[62:63], v5 offset:1024
  ds_read_b64_tr_b16 v[64:65], v4 offset:2048
  ds_read_b64_tr_b16 v[66:67], v4 offset:3072
  ds_read_b64_tr_b16 v[68:69], v5 offset:2048
  ds_read_b64_tr_b16 v[70:71], v5 offset:3072
  ds_read_b64_tr_b16 v[72:73], v4 offset:4096
  ds_read_b64_tr_b16 v[74:75], v4 offset:5120
  ds_read_b64_tr_b16 v[76:77], v5 offset:4096
  ds_read_b64_tr_b16 v[78:79], v5 offset:5120
  v_add_f32 v80, v80, v96
  v_add_f32 v81, v81, v97
  v_add_f32 v82, v82, v98
  v_add_f32 v83, v83, v99
  v_add_f32 v84, v84, v100
  v_add_f32 v85, v85, v101
  v_add_f32 v86, v86, v102
  v_add_f32 v87, v87, v103
  v_add_f32 v88, v88, v104
  v_add_f32 v89, v89, v105
  v_add_f32 v90, v90, v106
  v_add_f32 v91, v91, v107
  v_add_f32 v92, v92, v108
  v_add_f32 v93, v93, v109
  v_add_f32 v94, v94, v110
  v_add_f32 v95, v95, v111
  v_mul_f32 v80, v11, v80
  v_mul_f32 v81, v11, v81
  v_mul_f32 v82, v11, v82
  v_mul_f32 v83, v11, v83
  v_mul_f32 v84, v11, v84
  v_mul_f32 v85, v11, v85
  v_mul_f32 v86, v11, v86
  v_mul_f32 v87, v11, v87
  v_mul_f32 v88, v11, v88
  v_mul_f32 v89, v11, v89
  v_mul_f32 v90, v11, v90
  v_mul_f32 v91, v11, v91
  v_mul_f32 v92, v11, v92
  v_mul_f32 v93, v11, v93
  v_mul_f32 v94, v11, v94
  v_mul_f32 v95, v11, v95
  s_mov_b64 exec, 1
  v_mov_b32 v12, 0
  buffer_atomic_or v12, v8, s[24:27], s28 offen sc0 sc1
  s_mov_b64 exec, -1
  v_cvt_pk_bf16_f32 v16, v80, v81
  v_cvt_pk_bf16_f32 v17, v82, v83
  v_cvt_pk_bf16_f32 v18, v84, v85
  v_cvt_pk_bf16_f32 v19, v86, v87
  v_cvt_pk_bf16_f32 v20, v88, v89
  v_cvt_pk_bf16_f32 v21, v90, v91
  v_cvt_pk_bf16_f32 v22, v92, v93
  v_cvt_pk_bf16_f32 v23, v94, v95
  v_sub_f32 v11, 1.0, v11
  v_cvt_pk_bf16_f32 v11, v11, v11
  v_and_b32 v11, 0xffff0000, v11
  s_sleep 2
  s_mov_b64 exec, 1
KW15:
  v_mov_b32 v14, 0
  buffer_atomic_or v14, v8, s[24:27], s28 offen sc0 sc1
  s_waitcnt vmcnt(2)
  v_readfirstlane_b32 s36, v13
  s_nop 0
  s_andn2_b32 s37, s35, s36
  s_cbranch_scc0 KD16
  v_mov_b32 v13, 0
  buffer_atomic_or v13, v8, s[24:27], s28 offen sc0 sc1
  s_waitcnt vmcnt(2)
  v_readfirstlane_b32 s36, v12
  s_nop 0
  s_andn2_b32 s37, s35, s36
  s_cbranch_scc0 KD16
  v_mov_b32 v12, 0
  buffer_atomic_or v12, v8, s[24:27], s28 offen sc0 sc1
  s_waitcnt vmcnt(2)
  v_readfirstlane_b32 s36, v14
  s_nop 0
  s_andn2_b32 s37, s35, s36
  s_cbranch_scc0 KD16
  s_add_u32 s38, s38, 1
  s_cmp_lt_u32 s38, 0x30d40
  s_cbranch_scc1 KW15
  s_mov_b32 s36, -1
KD16:
  s_mov_b64 exec, -1
  buffer_load_dwordx4 v[80:83], v3, s[24:27], s34 offen offset:0 sc1
  buffer_load_dwordx4 v[84:87], v3, s[24:27], s34 offen offset:2048 sc1
  s_add_u32 s34, s34, 4096
  buffer_load_dwordx4 v[88:91], v3, s[24:27], s34 offen offset:0 sc1
  buffer_load_dwordx4 v[92:95], v3, s[24:27], s34 offen offset:2048 sc1
  s_add_u32 s34, s34, 4096
  buffer_load_dwordx4 v[96:99], v3, s[24:27], s34 offen offset:0 sc1
  buffer_load_dwordx4 v[100:103], v3, s[24:27], s34 offen offset:2048 sc1
  s_add_u32 s34, s34, 4096
  buffer_load_dwordx4 v[104:107], v3, s[24:27], s34 offen offset:0 sc1
  buffer_load_dwordx4 v[108:111], v3, s[24:27], s34 offen offset:2048 sc1
  s_add_u32 s34, s34, 4096
  buffer_load_dwordx4 v[112:115], v3, s[24:27], s34 offen offset:0 sc1
  buffer_load_dwordx4 v[116:119], v3, s[24:27], s34 offen offset:2048 sc1
  s_add_u32 s34, s34, 4096
  buffer_load_dwordx4 v[120:123], v3, s[24:27], s34 offen offset:0 sc1
  buffer_load_dwordx4 v[124:127], v3, s[24:27], s34 offen offset:2048 sc1
  s_add_u32 s34, s34, 4096
  s_waitcnt vmcnt(11) lgkmcnt(8)
  v_mfma_f32_32x32x16_bf16 v[24:39], v[56:59], v[80:83], 0
  v_mfma_f32_32x32x16_bf16 v[40:55], v[60:63], v[80:83], 0
  buffer_load_dwordx4 v[80:83], v3, s[24:27], s34 offen offset:0 sc1
  ds_read_b64_tr_b16 v[56:57], v4 offset:6144
  ds_read_b64_tr_b16 v[58:59], v4 offset:7168
  ds_read_b64_tr_b16 v[60:61], v5 offset:6144
  ds_read_b64_tr_b16 v[62:63], v5 offset:7168
  s_waitcnt vmcnt(11) lgkmcnt(8)
  v_mfma_f32_32x32x16_bf16 v[24:39], v[64:67], v[84:87], v[24:39]
  v_mfma_f32_32x32x16_bf16 v[40:55], v[68:71], v[84:87], v[40:55]
  buffer_load_dwordx4 v[84:87], v3, s[24:27], s34 offen offset:2048 sc1
  s_add_u32 s34, s34, 4096
  ds_read_b64_tr_b16 v[64:65], v4 offset:8192
  ds_read_b64_tr_b16 v[66:67], v4 offset:9216
  ds_read_b64_tr_b16 v[68:69], v5 offset:8192
  ds_read_b64_tr_b16 v[70:71], v5 offset:9216
  s_waitcnt vmcnt(11) lgkmcnt(8)
  v_mfma_f32_32x32x16_bf16 v[24:39], v[72:75], v[88:91], v[24:39]
  v_mfma_f32_32x32x16_bf16 v[40:55], v[76:79], v[88:91], v[40:55]
  buffer_load_dwordx4 v[88:91], v3, s[24:27], s34 offen offset:0 sc1
  ds_read_b64_tr_b16 v[72:73], v4 offset:10240
  ds_read_b64_tr_b16 v[74:75], v4 offset:11264
  ds_read_b64_tr_b16 v[76:77], v5 offset:10240
  ds_read_b64_tr_b16 v[78:79], v5 offset:11264
  s_waitcnt vmcnt(11) lgkmcnt(8)
  v_mfma_f32_32x32x16_bf16 v[24:39], v[56:59], v[92:95], v[24:39]
  v_mfma_f32_32x32x16_bf16 v[40:55], v[60:63], v[92:95], v[40:55]
  buffer_load_dwordx4 v[92:95], v3, s[24:27], s34 offen offset:2048 sc1
  ds_read_b64_tr_b16 v[56:57], v4 offset:12288
  ds_read_b64_tr_b16 v[58:59], v4 offset:13312
  ds_read_b64_tr_b16 v[60:61], v5 offset:12288
  ds_read_b64_tr_b16 v[62:63], v5 offset:13312
  s_waitcnt vmcnt(11) lgkmcnt(8)
  v_mfma_f32_32x32x16_bf16 v[24:39], v[64:67], v[96:99], v[24:39]
  v_mfma_f32_32x32x16_bf16 v[40:55], v[68:71], v[96:99], v[40:55]
  ds_read_b64_tr_b16 v[64:65], v4 offset:14336
  ds_read_b64_tr_b16 v[66:67], v4 offset:15360
  ds_read_b64_tr_b16 v[68:69], v5 offset:14336
  ds_read_b64_tr_b16 v[70:71], v5 offset:15360
  s_waitcnt vmcnt(10) lgkmcnt(8)
  v_mfma_f32_32x32x16_bf16 v[24:39], v[72:75], v[100:103], v[24:39]
  v_mfma_f32_32x32x16_bf16 v[40:55], v[76:79], v[100:103], v[40:55]
  ds_read_b64_tr_b16 v[72:73], v4 offset:16384
  ds_read_b64_tr_b16 v[74:75], v4 offset:17408
  ds_read_b64_tr_b16 v[76:77], v5 offset:16384
  ds_read_b64_tr_b16 v[78:79], v5 offset:17408
  s_waitcnt vmcnt(9) lgkmcnt(8)
  v_mfma_f32_32x32x16_bf16 v[24:39], v[56:59], v[104:107], v[24:39]
  v_mfma_f32_32x32x16_bf16 v[40:55], v[60:63], v[104:107], v[40:55]
  ds_read_b64_tr_b16 v[56:57], v4 offset:18432
  ds_read_b64_tr_b16 v[58:59], v4 offset:19456
  ds_read_b64_tr_b16 v[60:61], v5 offset:18432
  ds_read_b64_tr_b16 v[62:63], v5 offset:19456
  s_waitcnt vmcnt(8) lgkmcnt(8)
  v_mfma_f32_32x32x16_bf16 v[24:39], v[64:67], v[108:111], v[24:39]
  v_mfma_f32_32x32x16_bf16 v[40:55], v[68:71], v[108:111], v[40:55]
  ds_read_b64_tr_b16 v[64:65], v4 offset:20480
  ds_read_b64_tr_b16 v[66:67], v4 offset:21504
  ds_read_b64_tr_b16 v[68:69], v5 offset:20480
  ds_read_b64_tr_b16 v[70:71], v5 offset:21504
  s_waitcnt vmcnt(7) lgkmcnt(8)
  v_mfma_f32_32x32x16_bf16 v[24:39], v[72:75], v[112:115], v[24:39]
  v_mfma_f32_32x32x16_bf16 v[40:55], v[76:79], v[112:115], v[40:55]
  ds_read_b64_tr_b16 v[72:73], v4 offset:22528
  ds_read_b64_tr_b16 v[74:75], v4 offset:23552
  ds_read_b64_tr_b16 v[76:77], v5 offset:22528
  ds_read_b64_tr_b16 v[78:79], v5 offset:23552
  s_waitcnt vmcnt(6) lgkmcnt(8)
  v_mfma_f32_32x32x16_bf16 v[24:39], v[56:59], v[116:119], v[24:39]
  v_mfma_f32_32x32x16_bf16 v[40:55], v[60:63], v[116:119], v[40:55]
  ds_read_b64_tr_b16 v[56:57], v4 offset:24576
  ds_read_b64_tr_b16 v[58:59], v4 offset:25600
  ds_read_b64_tr_b16 v[60:61], v5 offset:24576
  ds_read_b64_tr_b16 v[62:63], v5 offset:25600
  s_waitcnt vmcnt(5) lgkmcnt(8)
  v_mfma_f32_32x32x16_bf16 v[24:39], v[64:67], v[120:123], v[24:39]
  v_mfma_f32_32x32x16_bf16 v[40:55], v[68:71], v[120:123], v[40:55]
  ds_read_b64_tr_b16 v[64:65], v4 offset:26624
  ds_read_b64_tr_b16 v[66:67], v4 offset:27648
  ds_read_b64_tr_b16 v[68:69], v5 offset:26624
  ds_read_b64_tr_b16 v[70:71], v5 offset:27648
  s_waitcnt vmcnt(4) lgkmcnt(8)
  v_mfma_f32_32x32x16_bf16 v[24:39], v[72:75], v[124:127], v[24:39]
  v_mfma_f32_32x32x16_bf16 v[40:55], v[76:79], v[124:127], v[40:55]
  ds_read_b64_tr_b16 v[72:73], v4 offset:28672
  ds_read_b64_tr_b16 v[74:75], v4 offset:29696
  ds_read_b64_tr_b16 v[76:77], v5 offset:28672
  ds_read_b64_tr_b16 v[78:79], v5 offset:29696
  s_waitcnt vmcnt(3) lgkmcnt(8)
  v_mfma_f32_32x32x16_bf16 v[24:39], v[56:59], v[80:83], v[24:39]
  v_mfma_f32_32x32x16_bf16 v[40:55], v[60:63], v[80:83], v[40:55]
  ds_read_b64_tr_b16 v[56:57], v4 offset:30720
  ds_read_b64_tr_b16 v[58:59], v4 offset:31744
  ds_read_b64_tr_b16 v[60:61], v5 offset:30720
  ds_read_b64_tr_b16 v[62:63], v5 offset:31744
  s_waitcnt vmcnt(2) lgkmcnt(8)
  v_mfma_f32_32x32x16_bf16 v[24:39], v[64:67], v[84:87], v[24:39]
  v_mfma_f32_32x32x16_bf16 v[40:55], v[68:71], v[84:87], v[40:55]
  s_waitcnt vmcnt(1) lgkmcnt(4)
  v_mfma_f32_32x32x16_bf16 v[24:39], v[72:75], v[88:91], v[24:39]
  v_mfma_f32_32x32x16_bf16 v[40:55], v[76:79], v[88:91], v[40:55]
  s_waitcnt vmcnt(0) lgkmcnt(0)
  v_mfma_f32_32x32x16_bf16 v[24:39], v[56:59], v[92:95], v[24:39]
  v_mfma_f32_32x32x16_bf16 v[40:55], v[60:63], v[92:95], v[40:55]
  v_lshlrev_b32 v96, 16, v16
  v_and_b32 v97, 0xffff0000, v16
  v_lshlrev_b32 v98, 16, v17
  v_and_b32 v99, 0xffff0000, v17
  v_lshlrev_b32 v100, 16, v18
  v_and_b32 v101, 0xffff0000, v18
  v_lshlrev_b32 v102, 16, v19
  v_lshlrev_b32 v104, 16, v20
  v_lshlrev_b32 v106, 16, v21
  v_lshlrev_b32 v108, 16, v22
  v_lshlrev_b32 v110, 16, v23
  ds_write_b128 v7, v[24:27] offset:0
  ds_write_b128 v7, v[28:31] offset:1024
  ds_write_b128 v7, v[32:35] offset:2048
  ds_write_b128 v7, v[36:39] offset:3072
  v_and_b32 v103, 0xffff0000, v19
  v_and_b32 v105, 0xffff0000, v20
  v_and_b32 v107, 0xffff0000, v21
  v_and_b32 v109, 0xffff0000, v22
  v_and_b32 v111, 0xffff0000, v23
  v_fma_f32 v96, v40, v11, v96
  v_fma_f32 v97, v41, v11, v97
  v_fma_f32 v98, v42, v11, v98
  v_fma_f32 v99, v43, v11, v99
  v_fma_f32 v100, v44, v11, v100
  v_fma_f32 v101, v45, v11, v101
  v_fma_f32 v102, v46, v11, v102
  v_fma_f32 v103, v47, v11, v103
  v_fma_f32 v104, v48, v11, v104
  v_fma_f32 v105, v49, v11, v105
  v_fma_f32 v106, v50, v11, v106
  v_fma_f32 v107, v51, v11, v107
  v_fma_f32 v108, v52, v11, v108
  v_fma_f32 v109, v53, v11, v109
  v_fma_f32 v110, v54, v11, v110
  v_fma_f32 v111, v55, v11, v111
  s_waitcnt lgkmcnt(0)
  s_barrier
  ds_read_b128 v[40:43], v0 offset:0
  ds_read_b128 v[44:47], v0 offset:1024
  ds_read_b128 v[48:51], v0 offset:2048
  ds_read_b128 v[52:55], v0 offset:3072
  s_mov_b64 vcc, s[40:41]
  s_waitcnt lgkmcnt(2)
  v_fma_f32 v96, v40, v11, v96
  v_fma_f32 v97, v41, v11, v97
  v_fma_f32 v98, v42, v11, v98
  v_fma_f32 v99, v43, v11, v99
  v_fma_f32 v100, v44, v11, v100
  v_fma_f32 v101, v45, v11, v101
  v_fma_f32 v102, v46, v11, v102
  v_fma_f32 v103, v47, v11, v103
  v_cvt_pk_bf16_f32 v16, v96, v97
  v_cvt_pk_bf16_f32 v17, v98, v99
  v_cvt_pk_bf16_f32 v18, v100, v101
  v_cvt_pk_bf16_f32 v19, v102, v103
  s_waitcnt lgkmcnt(0)
  v_fma_f32 v104, v48, v11, v104
  v_fma_f32 v105, v49, v11, v105
  v_fma_f32 v106, v50, v11, v106
  v_fma_f32 v107, v51, v11, v107
  v_fma_f32 v108, v52, v11, v108
  v_fma_f32 v109, v53, v11, v109
  v_fma_f32 v110, v54, v11, v110
  v_fma_f32 v111, v55, v11, v111
  v_cvt_pk_bf16_f32 v20, v104, v105
  v_cvt_pk_bf16_f32 v21, v106, v107
  v_cvt_pk_bf16_f32 v22, v108, v109
  v_cvt_pk_bf16_f32 v23, v110, v111
  v_cndmask_b32_dpp v24, v20, v16, vcc quad_perm:[1,0,3,2] row_mask:0xf bank_mask:0xf
  v_cndmask_b32_dpp v25, v21, v17, vcc quad_perm:[1,0,3,2] row_mask:0xf bank_mask:0xf
  v_cndmask_b32_dpp v26, v22, v18, vcc quad_perm:[1,0,3,2] row_mask:0xf bank_mask:0xf
  v_cndmask_b32_dpp v27, v23, v19, vcc quad_perm:[1,0,3,2] row_mask:0xf bank_mask:0xf
  s_not_b64 vcc, vcc
  v_cndmask_b32_dpp v28, v16, v20, vcc quad_perm:[1,0,3,2] row_mask:0xf bank_mask:0xf
  v_cndmask_b32_dpp v29, v17, v21, vcc quad_perm:[1,0,3,2] row_mask:0xf bank_mask:0xf
  v_cndmask_b32_dpp v30, v18, v22, vcc quad_perm:[1,0,3,2] row_mask:0xf bank_mask:0xf
  v_cndmask_b32_dpp v31, v19, v23, vcc quad_perm:[1,0,3,2] row_mask:0xf bank_mask:0xf
  s_mov_b64 vcc, s[42:43]
  v_permlane32_swap_b32 v24, v28
  v_permlane32_swap_b32 v25, v29
  v_permlane32_swap_b32 v26, v30
  v_permlane32_swap_b32 v27, v31
  v_cndmask_b32_dpp v16, v28, v24, vcc quad_perm:[2,3,0,1] row_mask:0xf bank_mask:0xf
  v_cndmask_b32_dpp v17, v29, v25, vcc quad_perm:[2,3,0,1] row_mask:0xf bank_mask:0xf
  v_cndmask_b32_dpp v18, v30, v26, vcc quad_perm:[2,3,0,1] row_mask:0xf bank_mask:0xf
  v_cndmask_b32_dpp v19, v31, v27, vcc quad_perm:[2,3,0,1] row_mask:0xf bank_mask:0xf
  s_not_b64 vcc, vcc
  v_cndmask_b32_dpp v20, v24, v28, vcc quad_perm:[2,3,0,1] row_mask:0xf bank_mask:0xf
  v_cndmask_b32_dpp v21, v25, v29, vcc quad_perm:[2,3,0,1] row_mask:0xf bank_mask:0xf
  v_cndmask_b32_dpp v22, v26, v30, vcc quad_perm:[2,3,0,1] row_mask:0xf bank_mask:0xf
  v_cndmask_b32_dpp v23, v27, v31, vcc quad_perm:[2,3,0,1] row_mask:0xf bank_mask:0xf
  buffer_store_dwordx4 v[16:19], v6, s[20:23], s32 offen sc1
  buffer_store_dwordx4 v[20:23], v6, s[20:23], s32 offen offset:2048 sc1
  s_endpgm
F_notloader:
  s_waitcnt lgkmcnt(0)
F_nl2:
  s_mov_b32 s8, s54
  s_mov_b32 s9, s55
  s_mov_b32 s24, s54
  s_mov_b32 s25, s55
  s_mov_b32 s26, 0xc00000
  s_mov_b32 s27, 0x20000
  s_cmp_lt_u32 s15, 4
  s_cbranch_scc1 F_gemm
  s_cmp_lt_u32 s15, 8
  s_cbranch_scc1 F_kgen
  v_mov_b32 v8, 0
  v_mov_b32 v9, 1
  s_setprio 3
  s_cmp_eq_u32 s15, 14
  s_cbranch_scc0 F_gate
  s_mov_b32 s36, s52
  s_mov_b32 s37, s53
  s_mov_b32 s38, 0x100
  s_mov_b32 s39, 0x20000
  v_and_b32 v5, 15, v1
  v_min_u32 v2, 3, v1
  v_lshlrev_b32 v2, 2, v2
  v_bfe_u32 v4, v1, 3, 1
  v_bfe_u32 v6, v1, 1, 1
  v_lshl_or_b32 v4, v4, 1, v6
  v_lshlrev_b32 v4, 4, v4
  v_lshl_add_u32 v4, v5, 7, v4
  v_bfe_u32 v6, v1, 4, 1
  v_lshl_add_u32 v4, v6, 12, v4
  v_lshrrev_b32 v6, 5, v1
  v_lshl_add_u32 v4, v6, 3, v4
  v_add_u32 v20, 32768, v4
  v_xor_b32 v21, 16, v20
  v_xor_b32 v22, 32, v20
  v_xor_b32 v23, 48, v20
  v_xor_b32 v24, 64, v20
  v_xor_b32 v25, 80, v20
  v_xor_b32 v26, 96, v20
  v_xor_b32 v27, 112, v20
  v_bfe_u32 v4, v1, 2, 3
  v_lshlrev_b32 v4, 5, v4
  v_lshl_add_u32 v7, v6, 14, v4
  v_and_b32 v4, 1, v1
  v_lshl_add_u32 v7, v4, 4, v7
  v_bfe_u32 v4, v1, 1, 1
  v_lshl_add_u32 v7, v4, 13, v7
  s_lshl_b32 s31, s14, 18
  s_lshl_b32 s32, s12, 8
  s_add_u32 s31, s31, s32
  s_add_u32 s31, s31, 0x604000
  s_lshl_b32 s33, s14, 12
  s_add_u32 s33, s33, 0xa06000
  v_lshlrev_b32 v11, 7, v1
  v_lshlrev_b32 v12, s12, v9
  s_barrier
  s_mov_b32 s35, 0
MW17:
  ds_read_b128 v[16:19], v8 offset:576
  s_waitcnt lgkmcnt(0)
  v_min3_u32 v16, v16, v17, v18
  v_min_u32 v16, v16, v19
  s_add_u32 s35, s35, 1
  v_readfirstlane_b32 s34, v16
  s_nop 0
  s_cmp_lg_u32 s34, 0
  s_cbranch_scc1 MD18
  s_sleep 1
  s_cmp_lt_u32 s35, 0x186a00
  s_cbranch_scc1 MW17
MD18:
  ds_read_b64_tr_b16 v[32:33], v20 offset:0
  ds_read_b64_tr_b16 v[34:35], v24 offset:2048
  ds_read_b64_tr_b16 v[36:37], v21 offset:0
  ds_read_b64_tr_b16 v[38:39], v25 offset:2048
  ds_read_b64_tr_b16 v[40:41], v22 offset:0
  ds_read_b64_tr_b16 v[42:43], v26 offset:2048
  ds_read_b64_tr_b16 v[44:45], v23 offset:0
  ds_read_b64_tr_b16 v[46:47], v27 offset:2048
  ds_read_b64_tr_b16 v[48:49], v24 offset:0
  ds_read_b64_tr_b16 v[50:51], v20 offset:2048
  ds_read_b64_tr_b16 v[52:53], v25 offset:0
  ds_read_b64_tr_b16 v[54:55], v21 offset:2048
  ds_read_b64_tr_b16 v[56:57], v26 offset:0
  ds_read_b64_tr_b16 v[58:59], v22 offset:2048
  ds_read_b64_tr_b16 v[60:61], v27 offset:0
  ds_read_b64_tr_b16 v[62:63], v23 offset:2048
  s_waitcnt lgkmcnt(12)
  buffer_store_dwordx4 v[32:35], v7, s[24:27], s31 offen sc1
  s_add_u32 s31, s31, 0x8000
  buffer_store_dwordx4 v[36:39], v7, s[24:27], s31 offen sc1
  s_add_u32 s31, s31, 0x8000
  s_waitcnt lgkmcnt(8)
  buffer_store_dwordx4 v[40:43], v7, s[24:27], s31 offen sc1
  s_add_u32 s31, s31, 0x8000
  buffer_store_dwordx4 v[44:47], v7, s[24:27], s31 offen sc1
  s_add_u32 s31, s31, 0x8000
  s_waitcnt lgkmcnt(4)
  buffer_store_dwordx4 v[48:51], v7, s[24:27], s31 offen sc1
  s_add_u32 s31, s31, 0x8000
  buffer_store_dwordx4 v[52:55], v7, s[24:27], s31 offen sc1
  s_add_u32 s31, s31, 0x8000
  s_waitcnt lgkmcnt(0)
  buffer_store_dwordx4 v[56:59], v7, s[24:27], s31 offen sc1
  s_add_u32 s31, s31, 0x8000
  buffer_store_dwordx4 v[60:63], v7, s[24:27], s31 offen sc1
  buffer_load_dword v10, v2, s[36:39], 0 offen sc1
  s_barrier
  s_waitcnt vmcnt(0)
  v_cmp_eq_u32 vcc, 1, v10
  s_nop 1
  s_cmp_eq_u64 vcc, -1
  s_cbranch_scc1 F_m2
  s_mov_b32 s34, 0
FW19:
  buffer_load_dword v10, v2, s[36:39], 0 offen sc1
  s_waitcnt vmcnt(0)
  v_cmp_eq_u32 vcc, 1, v10
  s_add_u32 s34, s34, 1
  s_cmp_eq_u64 vcc, -1
  s_cbranch_scc1 FD20
  s_sleep 2
  s_cmp_lt_u32 s34, 0x30d40
  s_cbranch_scc1 FW19
FD20:
F_m2:
  s_mov_b32 exec_hi, 0
  buffer_atomic_or v12, v11, s[24:27], s33 offen sc1
  s_mov_b64 exec, -1
  s_endpgm
F_gate:
  v_mov_b32 v16, 0
  v_mov_b32 v17, 0
  v_mov_b32 v18, 0
  v_mov_b32 v19, 0
  v_mov_b32 v20, 0
  v_mov_b32 v21, 0
  v_mov_b32 v22, 0
  v_mov_b32 v23, 0
  v_mov_b32 v48, 0
  v_mov_b32 v49, 0
  v_mov_b32 v50, 0
  v_mov_b32 v51, 0
  v_mov_b32 v52, 0
  v_mov_b32 v53, 0
  v_mov_b32 v54, 0
  v_mov_b32 v55, 0
  v_mov_b32 v56, 0
  v_mov_b32 v57, 0
  v_mov_b32 v58, 0
  v_mov_b32 v59, 0
  v_mov_b32 v60, 0
  v_mov_b32 v61, 0
  v_mov_b32 v62, 0
  v_mov_b32 v63, 0
  v_mov_b32 v68, 0
  v_mov_b32 v69, 0
  v_mov_b32 v70, 0
  v_mov_b32 v71, 0
  v_mov_b32 v72, 0
  v_mov_b32 v73, 0
  v_mov_b32 v74, 0
  v_mov_b32 v75, 0
  v_and_b32 v2, 15, v1
  v_lshrrev_b32 v3, 4, v1
  v_lshrrev_b32 v7, 2, v2
  v_and_b32 v8, 3, v1
  v_lshl_add_u32 v9, v7, 3, v8
  v_lshrrev_b32 v10, 1, v8
  v_lshl_or_b32 v10, v7, 1, v10
  v_xor_b32 v10, v10, v3
  v_lshlrev_b32 v10, 4, v10
  v_lshl_add_u32 v4, v9, 7, v10
  v_add_u32 v4, 32768, v4
  v_xor_b32 v5, 64, v4
  s_sub_u32 s16, s15, 12
  s_lshl_b32 s30, s16, 12
  v_add_u32 v4, s30, v4
  v_add_u32 v5, s30, v5
  s_lshl_b32 s30, s16, 7
  v_lshl_add_u32 v10, v9, 2, s30
  v_mov_b32 v8, 0
  v_mov_b32 v9, 1
  s_lshl_b32 s30, s14, 1
  s_mov_b32 s31, 4
  s_barrier
  s_waitcnt vmcnt(0)
  v_mov_b32 v6, 0
F_gt:
  s_mov_b32 s35, 0
MW21:
  ds_read_b128 v[76:79], v6 offset:576
  s_waitcnt lgkmcnt(0)
  v_min3_u32 v76, v76, v77, v78
  v_min_u32 v76, v76, v79
  s_add_u32 s35, s35, 1
  v_readfirstlane_b32 s34, v76
  s_nop 0
  s_cmp_lg_u32 s34, 0
  s_cbranch_scc1 MD22
  s_sleep 1
  s_cmp_lt_u32 s35, 0x186a00
  s_cbranch_scc1 MW21
MD22:
  ds_read_b128 v[32:35], v4 offset:0
  ds_read_b128 v[36:39], v4 offset:512
  ds_read_b128 v[40:43], v5 offset:0
  ds_read_b128 v[44:47], v5 offset:512
  v_mfma_f32_16x16x32_bf16 v[16:19], v[68:71], v[48:51], v[16:19]
  v_mfma_f32_16x16x32_bf16 v[20:23], v[68:71], v[52:55], v[20:23]
  v_mfma_f32_16x16x32_bf16 v[16:19], v[72:75], v[56:59], v[16:19]
  v_mfma_f32_16x16x32_bf16 v[20:23], v[72:75], v[60:63], v[20:23]
  v_cmp_eq_u32 vcc, s30, v2
  s_add_u32 s30, s30, 1
  s_and_b32 s30, s30, 15
  v_cndmask_b32 v68, 0, v64, vcc
  v_cndmask_b32 v69, 0, v65, vcc
  v_cndmask_b32 v70, 0, v66, vcc
  v_cndmask_b32 v71, 0, v67, vcc
  v_cmp_eq_u32 vcc, s30, v2
  s_add_u32 s30, s30, 1
  s_and_b32 s30, s30, 15
  v_cndmask_b32 v72, 0, v64, vcc
  v_cndmask_b32 v73, 0, v65, vcc
  v_cndmask_b32 v74, 0, v66, vcc
  v_cndmask_b32 v75, 0, v67, vcc
  s_waitcnt lgkmcnt(0)
  s_barrier
  s_mov_b32 s35, 0
MW23:
  ds_read_b128 v[76:79], v6 offset:592
  s_waitcnt lgkmcnt(0)
  v_min3_u32 v76, v76, v77, v78
  v_min_u32 v76, v76, v79
  s_add_u32 s35, s35, 1
  v_readfirstlane_b32 s34, v76
  s_nop 0
  s_cmp_lg_u32 s34, 0
  s_cbranch_scc1 MD24
  s_sleep 1
  s_cmp_lt_u32 s35, 0x186a00
  s_cbranch_scc1 MW23
MD24:
  ds_read_b128 v[48:51], v4 offset:32768
  ds_read_b128 v[52:55], v4 offset:33280
  ds_read_b128 v[56:59], v5 offset:32768
  ds_read_b128 v[60:63], v5 offset:33280
  v_mfma_f32_16x16x32_bf16 v[16:19], v[68:71], v[32:35], v[16:19]
  v_mfma_f32_16x16x32_bf16 v[20:23], v[68:71], v[36:39], v[20:23]
  v_mfma_f32_16x16x32_bf16 v[16:19], v[72:75], v[40:43], v[16:19]
  v_mfma_f32_16x16x32_bf16 v[20:23], v[72:75], v[44:47], v[20:23]
  v_cmp_eq_u32 vcc, s30, v2
  s_add_u32 s30, s30, 1
  s_and_b32 s30, s30, 15
  v_cndmask_b32 v68, 0, v64, vcc
  v_cndmask_b32 v69, 0, v65, vcc
  v_cndmask_b32 v70, 0, v66, vcc
  v_cndmask_b32 v71, 0, v67, vcc
  v_cmp_eq_u32 vcc, s30, v2
  s_add_u32 s30, s30, 1
  s_and_b32 s30, s30, 15
  v_cndmask_b32 v72, 0, v64, vcc
  v_cndmask_b32 v73, 0, v65, vcc
  v_cndmask_b32 v74, 0, v66, vcc
  v_cndmask_b32 v75, 0, v67, vcc
  v_xor_b32 v4, 0x10000, v4
  v_xor_b32 v5, 0x10000, v5
  v_add_u32 v6, 32, v6
  s_sub_u32 s31, s31, 1
  s_cmp_lg_u32 s31, 0
  s_waitcnt lgkmcnt(0)
  s_cbranch_scc1 F_gt
  v_mfma_f32_16x16x32_bf16 v[16:19], v[68:71], v[48:51], v[16:19]
  v_mfma_f32_16x16x32_bf16 v[20:23], v[68:71], v[52:55], v[20:23]
  v_mfma_f32_16x16x32_bf16 v[16:19], v[72:75], v[56:59], v[16:19]
  v_mfma_f32_16x16x32_bf16 v[20:23], v[72:75], v[60:63], v[20:23]
  s_mov_b64 exec, 1
  ds_add_u32 v8, v9 offset:96
  s_mov_b64 exec, -1
  s_nop 4
  v_add_f32 v16, v16, v17
  v_add_f32 v20, v20, v21
  v_add_f32 v18, v18, v19
  v_add_f32 v22, v22, v23
  v_add_f32 v16, v16, v18
  v_add_f32 v20, v20, v22
  v_mov_b32 v17, v16
  v_mov_b32 v21, v20
  s_nop 1
  v_permlane16_swap_b32 v16, v17
  v_permlane16_swap_b32 v20, v21
  s_nop 0
  v_add_f32 v16, v16, v17
  v_add_f32 v20, v20, v21
  v_mov_b32 v17, v16
  v_mov_b32 v21, v20
  s_nop 1
  v_permlane32_swap_b32 v16, v17
  v_permlane32_swap_b32 v20, v21
  s_nop 0
  v_add_f32 v16, v16, v17
  v_add_f32 v20, v20, v21
  v_cvt_pk_bf16_f32 v16, v16, v16
  v_cvt_pk_bf16_f32 v20, v20, v20
  v_and_b32 v16, 0xffff0000, v16
  v_and_b32 v20, 0xffff0000, v20
  v_mul_f32 v16, 0xbfb8aa3b, v16
  v_mul_f32 v20, 0xbfb8aa3b, v20
  v_exp_f32 v16, v16
  v_exp_f32 v20, v20
  v_add_f32 v16, 1.0, v16
  v_add_f32 v20, 1.0, v20
  v_rcp_f32 v16, v16
  v_rcp_f32 v20, v20
  v_cvt_pk_bf16_f32 v16, v16, v16
  v_cvt_pk_bf16_f32 v20, v20, v20
  v_and_b32 v16, 0xffff0000, v16
  v_and_b32 v20, 0xffff0000, v20
  ds_write_b32 v10, v16 offset:128
  ds_write_b32 v10, v20 offset:144
  s_mov_b64 exec, 1
  ds_add_u32 v8, v9 offset:16
  s_mov_b64 exec, -1
  s_waitcnt lgkmcnt(0)
  s_endpgm
F_kgen:
  s_mul_i32 s19, s16, 130304
  s_add_u32 s19, s19, 768
  s_bfe_u32 s22, s15, 0x10001
  s_add_u32 s20, s19, 16896
  v_and_b32 v16, 31, v1
  v_lshrrev_b32 v17, 5, v1
  v_lshlrev_b32 v17, 4, v17
  v_mul_u32_u24 v2, 528, v16
  v_add3_u32 v2, v2, v17, s19
  v_bfe_u32 v18, v1, 2, 1
  v_bfe_u32 v19, v1, 4, 1
  v_lshl_add_u32 v18, v19, 1, v18
  v_and_b32 v19, 3, v1
  v_bfe_u32 v20, v1, 3, 1
  v_lshl_add_u32 v19, v20, 2, v19
  s_mov_b32 s35, 0x11100000
  s_mov_b32 s36, 0x1a181614
  s_cmp_eq_u32 s22, 0
  s_cselect_b32 s32, 0x22111000, s35
  s_cselect_b32 s33, 0xd7ccc6bb, s35
  s_cselect_b32 s34, 0x54392108, s35
  s_cselect_b32 s35, 0x110e0000, s36
  v_mov_b32 v20, s32
  v_mov_b32 v21, s33
  v_mov_b32 v22, s34
  v_cmp_eq_u32 vcc, 1, v18
  v_lshlrev_b32 v23, 2, v19
  v_lshlrev_b32 v24, 3, v18
  v_cndmask_b32 v20, v20, v21, vcc
  v_cmp_eq_u32 vcc, 0, v18
  v_bfe_u32 v24, s35, v24, 8
  s_lshl_b32 s31, s22, 23
  v_cndmask_b32 v20, v20, v22, vcc
  v_bfe_u32 v20, v20, v23, 4
  v_add_u32 v20, v20, v24
  v_mul_u32_u24 v12, 528, v20
  v_add3_u32 v12, v12, v17, s20
  s_mul_i32 s31, s31, 9
  s_add_u32 s30, s31, 0x3fb8aa3b
  s_add_u32 s31, s31, 0x3e22f983
  s_mul_i32 s29, s22, 3168
  s_add_u32 s29, s29, s20
  v_lshl_add_u32 v13, v1, 3, s29
  s_setprio 1
  s_waitcnt vmcnt(0)
  v_lshlrev_b32 v14, 16, v10
  v_mul_f32 v14, 0x3fb8aa3b, v14
  v_exp_f32 v14, v14
  v_lshlrev_b32 v16, 16, v4
  v_and_b32 v17, 0xffff0000, v4
  v_cvt_pk_bf16_f32 v14, v14, v14
  v_lshlrev_b32 v18, 16, v5
  v_and_b32 v19, 0xffff0000, v5
  v_and_b32 v14, 0xffff0000, v14
  v_mul_f32 v16, v14, v16
  v_mul_f32 v17, v14, v17
  v_mul_f32 v18, v14, v18
  v_mul_f32 v19, v14, v19
  v_lshlrev_b32 v64, 16, v6
  v_and_b32 v66, 0xffff0000, v6
  v_lshlrev_b32 v65, 16, v7
  v_and_b32 v67, 0xffff0000, v7
  v_lshlrev_b32 v68, 16, v8
  v_and_b32 v70, 0xffff0000, v8
  v_lshlrev_b32 v69, 16, v9
  v_and_b32 v71, 0xffff0000, v9
  v_mul_f32 v64, v14, v64
  v_mul_f32 v65, v14, v65
  v_mul_f32 v66, v14, v66
  v_mul_f32 v67, v14, v67
  v_mul_f32 v48, s30, v16
  v_mul_f32 v56, s31, v18
  v_mul_f32 v49, s30, v17
  v_mul_f32 v57, s31, v19
  v_mul_f32 v50, 0x40b8aa3b, v16
  v_mul_f32 v58, 0x3f22f983, v18
  v_mul_f32 v51, 0x40b8aa3b, v17
  v_mul_f32 v59, 0x3f22f983, v19
  v_mul_f32 v52, 0x43b8aa3b, v16
  v_mul_f32 v60, 0x4222f983, v18
  v_mul_f32 v53, 0x43b8aa3b, v17
  v_mul_f32 v61, 0x4222f983, v19
  v_exp_f32 v48, v48
  v_fract_f32 v56, v56
  v_exp_f32 v49, v49
  v_fract_f32 v57, v57
  v_exp_f32 v50, v50
  v_fract_f32 v58, v58
  v_exp_f32 v51, v51
  v_fract_f32 v59, v59
  v_exp_f32 v52, v52
  v_fract_f32 v60, v60
  v_exp_f32 v53, v53
  v_fract_f32 v61, v61
  v_cos_f32 v20, v56
  v_sin_f32 v21, v56
  v_cos_f32 v22, v57
  v_sin_f32 v23, v57
  v_cos_f32 v24, v58
  v_sin_f32 v25, v58
  v_cos_f32 v26, v59
  v_sin_f32 v27, v59
  v_cos_f32 v28, v60
  v_sin_f32 v29, v60
  v_cos_f32 v30, v61
  v_sin_f32 v31, v61
  v_mul_f32 v20, v48, v20
  v_mul_f32 v21, v48, v21
  v_mul_f32 v22, v49, v22
  v_mul_f32 v23, v49, v23
  v_mul_f32 v24, v50, v24
  v_mul_f32 v25, v50, v25
  v_mul_f32 v26, v51, v26
  v_mul_f32 v27, v51, v27
  v_mul_f32 v28, v52, v28
  v_mul_f32 v29, v52, v29
  v_mul_f32 v30, v53, v30
  v_mul_f32 v31, v53, v31
.p2align 3
  v_pk_mul_f32 v[48:49], v[68:69], v[64:65] op_sel:[0,0] op_sel_hi:[1,0]
  v_pk_mul_f32 v[50:51], v[70:71], v[66:67] op_sel:[0,0] op_sel_hi:[1,0]
  v_pk_fma_f32 v[32:33], v[68:69], v[64:65], v[48:49] op_sel:[1,1,0] op_sel_hi:[0,1,1] neg_lo:[1,0,0]
  v_pk_fma_f32 v[34:35], v[70:71], v[66:67], v[50:51] op_sel:[1,1,0] op_sel_hi:[0,1,1] neg_lo:[1,0,0]
  s_cmp_eq_u32 s22, 0
  s_cbranch_scc1 F_kx0
  v_pk_mul_f32 v[48:49], v[32:33], v[20:21] op_sel:[0,0] op_sel_hi:[1,0]
  v_pk_mul_f32 v[50:51], v[34:35], v[22:23] op_sel:[0,0] op_sel_hi:[1,0]
  v_pk_fma_f32 v[32:33], v[32:33], v[20:21], v[48:49] op_sel:[1,1,0] op_sel_hi:[0,1,1] neg_lo:[1,0,0]
  v_pk_fma_f32 v[34:35], v[34:35], v[22:23], v[50:51] op_sel:[1,1,0] op_sel_hi:[0,1,1] neg_lo:[1,0,0]
F_kx0:
  v_cvt_pk_bf16_f32 v44, v32, -v33
  v_cvt_pk_bf16_f32 v45, v34, -v35
  ds_write_b64 v13, v[44:45] offset:4224
  v_pk_mul_f32 v[48:49], v[32:33], v[24:25] op_sel:[0,0] op_sel_hi:[1,0]
  v_pk_mul_f32 v[50:51], v[34:35], v[26:27] op_sel:[0,0] op_sel_hi:[1,0]
  v_pk_fma_f32 v[36:37], v[32:33], v[24:25], v[48:49] op_sel:[1,1,0] op_sel_hi:[0,1,1] neg_lo:[1,0,0]
  v_pk_fma_f32 v[38:39], v[34:35], v[26:27], v[50:51] op_sel:[1,1,0] op_sel_hi:[0,1,1] neg_lo:[1,0,0]
  v_cvt_pk_bf16_f32 v46, v36, -v37
  v_cvt_pk_bf16_f32 v47, v38, -v39
  ds_write_b64 v13, v[46:47] offset:4752
  v_pk_mul_f32 v[48:49], v[36:37], v[24:25] op_sel:[0,0] op_sel_hi:[1,0]
  v_pk_mul_f32 v[50:51], v[38:39], v[26:27] op_sel:[0,0] op_sel_hi:[1,0]
  v_pk_fma_f32 v[40:41], v[36:37], v[24:25], v[48:49] op_sel:[1,1,0] op_sel_hi:[0,1,1] neg_lo:[1,0,0]
  v_pk_fma_f32 v[42:43], v[38:39], v[26:27], v[50:51] op_sel:[1,1,0] op_sel_hi:[0,1,1] neg_lo:[1,0,0]
  v_cvt_pk_bf16_f32 v44, v40, -v41
  v_cvt_pk_bf16_f32 v45, v42, -v43
  ds_write_b64 v13, v[44:45] offset:5280
  s_cbranch_scc0 F_kx3
  s_nop 0
  v_pk_mul_f32 v[48:49], v[32:33], v[20:21] op_sel:[0,0] op_sel_hi:[1,0]
  v_pk_mul_f32 v[50:51], v[34:35], v[22:23] op_sel:[0,0] op_sel_hi:[1,0]
  v_pk_mul_f32 v[52:53], v[36:37], v[20:21] op_sel:[0,0] op_sel_hi:[1,0]
  v_pk_mul_f32 v[54:55], v[38:39], v[22:23] op_sel:[0,0] op_sel_hi:[1,0]
  v_pk_fma_f32 v[72:73], v[32:33], v[20:21], v[48:49] op_sel:[1,1,0] op_sel_hi:[0,1,1] neg_lo:[1,0,0]
  v_pk_fma_f32 v[74:75], v[34:35], v[22:23], v[50:51] op_sel:[1,1,0] op_sel_hi:[0,1,1] neg_lo:[1,0,0]
  v_pk_fma_f32 v[76:77], v[36:37], v[20:21], v[52:53] op_sel:[1,1,0] op_sel_hi:[0,1,1] neg_lo:[1,0,0]
  v_pk_fma_f32 v[78:79], v[38:39], v[22:23], v[54:55] op_sel:[1,1,0] op_sel_hi:[0,1,1] neg_lo:[1,0,0]
  v_cvt_pk_bf16_f32 v46, v72, -v73
  v_cvt_pk_bf16_f32 v47, v74, -v75
  ds_write_b64 v13, v[46:47] offset:0
  v_cvt_pk_bf16_f32 v44, v76, -v77
  v_cvt_pk_bf16_f32 v45, v78, -v79
  ds_write_b64 v13, v[44:45] offset:1584
  v_pk_mul_f32 v[48:49], v[72:73], v[20:21] op_sel:[0,0] op_sel_hi:[1,0]
  v_pk_mul_f32 v[50:51], v[74:75], v[22:23] op_sel:[0,0] op_sel_hi:[1,0]
  v_pk_mul_f32 v[52:53], v[76:77], v[20:21] op_sel:[0,0] op_sel_hi:[1,0]
  v_pk_mul_f32 v[54:55], v[78:79], v[22:23] op_sel:[0,0] op_sel_hi:[1,0]
  v_pk_fma_f32 v[72:73], v[72:73], v[20:21], v[48:49] op_sel:[1,1,0] op_sel_hi:[0,1,1] neg_lo:[1,0,0]
  v_pk_fma_f32 v[74:75], v[74:75], v[22:23], v[50:51] op_sel:[1,1,0] op_sel_hi:[0,1,1] neg_lo:[1,0,0]
  v_pk_fma_f32 v[76:77], v[76:77], v[20:21], v[52:53] op_sel:[1,1,0] op_sel_hi:[0,1,1] neg_lo:[1,0,0]
  v_pk_fma_f32 v[78:79], v[78:79], v[22:23], v[54:55] op_sel:[1,1,0] op_sel_hi:[0,1,1] neg_lo:[1,0,0]
  v_cvt_pk_bf16_f32 v46, v72, -v73
  v_cvt_pk_bf16_f32 v47, v74, -v75
  ds_write_b64 v13, v[46:47] offset:528
  v_cvt_pk_bf16_f32 v44, v76, -v77
  v_cvt_pk_bf16_f32 v45, v78, -v79
  ds_write_b64 v13, v[44:45] offset:2112
  v_pk_mul_f32 v[48:49], v[72:73], v[28:29] op_sel:[0,0] op_sel_hi:[1,0]
  v_pk_mul_f32 v[50:51], v[74:75], v[30:31] op_sel:[0,0] op_sel_hi:[1,0]
  v_pk_mul_f32 v[52:53], v[76:77], v[28:29] op_sel:[0,0] op_sel_hi:[1,0]
  v_pk_mul_f32 v[54:55], v[78:79], v[30:31] op_sel:[0,0] op_sel_hi:[1,0]
  v_pk_fma_f32 v[64:65], v[72:73], v[28:29], v[48:49] op_sel:[1,1,0] op_sel_hi:[0,1,1] neg_lo:[1,0,0]
  v_pk_fma_f32 v[66:67], v[74:75], v[30:31], v[50:51] op_sel:[1,1,0] op_sel_hi:[0,1,1] neg_lo:[1,0,0]
  v_pk_fma_f32 v[68:69], v[76:77], v[28:29], v[52:53] op_sel:[1,1,0] op_sel_hi:[0,1,1] neg_lo:[1,0,0]
  v_pk_fma_f32 v[70:71], v[78:79], v[30:31], v[54:55] op_sel:[1,1,0] op_sel_hi:[0,1,1] neg_lo:[1,0,0]
  v_cvt_pk_bf16_f32 v46, v64, -v65
  v_cvt_pk_bf16_f32 v47, v66, -v67
  ds_write_b64 v13, v[46:47] offset:3168
  v_cvt_pk_bf16_f32 v44, v68, -v69
  v_cvt_pk_bf16_f32 v45, v70, -v71
  ds_write_b64 v13, v[44:45] offset:3696
  v_pk_mul_f32 v[48:49], v[72:73], v[20:21] op_sel:[0,0] op_sel_hi:[1,0]
  v_pk_mul_f32 v[50:51], v[74:75], v[22:23] op_sel:[0,0] op_sel_hi:[1,0]
  v_pk_mul_f32 v[52:53], v[76:77], v[20:21] op_sel:[0,0] op_sel_hi:[1,0]
  v_pk_mul_f32 v[54:55], v[78:79], v[22:23] op_sel:[0,0] op_sel_hi:[1,0]
  v_pk_fma_f32 v[72:73], v[72:73], v[20:21], v[48:49] op_sel:[1,1,0] op_sel_hi:[0,1,1] neg_lo:[1,0,0]
  v_pk_fma_f32 v[74:75], v[74:75], v[22:23], v[50:51] op_sel:[1,1,0] op_sel_hi:[0,1,1] neg_lo:[1,0,0]
  v_pk_fma_f32 v[76:77], v[76:77], v[20:21], v[52:53] op_sel:[1,1,0] op_sel_hi:[0,1,1] neg_lo:[1,0,0]
  v_pk_fma_f32 v[78:79], v[78:79], v[22:23], v[54:55] op_sel:[1,1,0] op_sel_hi:[0,1,1] neg_lo:[1,0,0]
  v_cvt_pk_bf16_f32 v46, v72, -v73
  v_cvt_pk_bf16_f32 v47, v74, -v75
  ds_write_b64 v13, v[46:47] offset:1056
  v_cvt_pk_bf16_f32 v44, v76, -v77
  v_cvt_pk_bf16_f32 v45, v78, -v79
  ds_write_b64 v13, v[44:45] offset:2640
F_kx3:
  v_pk_mul_f32 v[48:49], v[32:33], v[28:29] op_sel:[0,0] op_sel_hi:[1,0]
  v_pk_mul_f32 v[50:51], v[34:35], v[30:31] op_sel:[0,0] op_sel_hi:[1,0]
  v_pk_mul_f32 v[52:53], v[36:37], v[28:29] op_sel:[0,0] op_sel_hi:[1,0]
  v_pk_mul_f32 v[54:55], v[38:39], v[30:31] op_sel:[0,0] op_sel_hi:[1,0]
  v_pk_mul_f32 v[56:57], v[40:41], v[28:29] op_sel:[0,0] op_sel_hi:[1,0]
  v_pk_mul_f32 v[58:59], v[42:43], v[30:31] op_sel:[0,0] op_sel_hi:[1,0]
  v_pk_fma_f32 v[32:33], v[32:33], v[28:29], v[48:49] op_sel:[1,1,0] op_sel_hi:[0,1,1] neg_lo:[1,0,0]
  v_pk_fma_f32 v[34:35], v[34:35], v[30:31], v[50:51] op_sel:[1,1,0] op_sel_hi:[0,1,1] neg_lo:[1,0,0]
  v_pk_fma_f32 v[36:37], v[36:37], v[28:29], v[52:53] op_sel:[1,1,0] op_sel_hi:[0,1,1] neg_lo:[1,0,0]
  v_pk_fma_f32 v[38:39], v[38:39], v[30:31], v[54:55] op_sel:[1,1,0] op_sel_hi:[0,1,1] neg_lo:[1,0,0]
  v_pk_fma_f32 v[40:41], v[40:41], v[28:29], v[56:57] op_sel:[1,1,0] op_sel_hi:[0,1,1] neg_lo:[1,0,0]
  v_pk_fma_f32 v[42:43], v[42:43], v[30:31], v[58:59] op_sel:[1,1,0] op_sel_hi:[0,1,1] neg_lo:[1,0,0]
  v_cvt_pk_bf16_f32 v46, v32, -v33
  v_cvt_pk_bf16_f32 v47, v34, -v35
  ds_write_b64 v13, v[46:47] offset:5808
  v_cvt_pk_bf16_f32 v44, v36, -v37
  v_cvt_pk_bf16_f32 v45, v38, -v39
  ds_write_b64 v13, v[44:45] offset:6336
  v_cvt_pk_bf16_f32 v46, v40, -v41
  v_cvt_pk_bf16_f32 v47, v42, -v43
  ds_write_b64 v13, v[46:47] offset:6864
  s_cbranch_scc1 F_kt
  s_mov_b32 s21, 3
F_kx2:
  s_sub_u32 s21, s21, 1
  s_nop 0
  v_pk_mul_f32 v[48:49], v[32:33], v[28:29] op_sel:[0,0] op_sel_hi:[1,0]
  v_pk_mul_f32 v[50:51], v[34:35], v[30:31] op_sel:[0,0] op_sel_hi:[1,0]
  v_pk_mul_f32 v[52:53], v[40:41], v[28:29] op_sel:[0,0] op_sel_hi:[1,0]
  v_pk_mul_f32 v[54:55], v[42:43], v[30:31] op_sel:[0,0] op_sel_hi:[1,0]
  v_pk_fma_f32 v[32:33], v[32:33], v[28:29], v[48:49] op_sel:[1,1,0] op_sel_hi:[0,1,1] neg_lo:[1,0,0]
  v_pk_fma_f32 v[34:35], v[34:35], v[30:31], v[50:51] op_sel:[1,1,0] op_sel_hi:[0,1,1] neg_lo:[1,0,0]
  v_pk_fma_f32 v[40:41], v[40:41], v[28:29], v[52:53] op_sel:[1,1,0] op_sel_hi:[0,1,1] neg_lo:[1,0,0]
  v_pk_fma_f32 v[42:43], v[42:43], v[30:31], v[54:55] op_sel:[1,1,0] op_sel_hi:[0,1,1] neg_lo:[1,0,0]
  v_cvt_pk_bf16_f32 v44, v32, -v33
  v_cvt_pk_bf16_f32 v45, v34, -v35
  ds_write_b64 v13, v[44:45] offset:7392
  v_cvt_pk_bf16_f32 v46, v40, -v41
  v_cvt_pk_bf16_f32 v47, v42, -v43
  ds_write_b64 v13, v[46:47] offset:7920
  v_add_u32 v13, 1056, v13
  s_cbranch_scc0 F_kx2
F_kt:
  s_setprio 0
  s_waitcnt lgkmcnt(0)
  s_barrier
  ds_read_b128 v[16:19], v12 offset:0
  ds_read_b128 v[20:23], v2 offset:0
  ds_read_b128 v[24:27], v12 offset:32
  ds_read_b128 v[28:31], v2 offset:32
  ds_read_b128 v[32:35], v12 offset:64
  ds_read_b128 v[36:39], v2 offset:64
  ds_read_b128 v[40:43], v12 offset:96
  ds_read_b128 v[44:47], v2 offset:96
  ds_read_b128 v[48:51], v12 offset:128
  ds_read_b128 v[52:55], v2 offset:128
  ds_read_b128 v[56:59], v12 offset:160
  ds_read_b128 v[60:63], v2 offset:160
  ds_read_b128 v[64:67], v12 offset:192
  ds_read_b128 v[68:71], v2 offset:192
  ds_read_b128 v[72:75], v12 offset:224
  ds_read_b128 v[76:79], v2 offset:224
  s_waitcnt lgkmcnt(14)
  v_mfma_f32_32x32x16_bf16 v[112:127], v[16:19], v[20:23], 0
  ds_read_b128 v[80:83], v12 offset:256
  ds_read_b128 v[84:87], v2 offset:256
  ds_read_b128 v[88:91], v12 offset:288
  ds_read_b128 v[92:95], v2 offset:288
  s_waitcnt lgkmcnt(14)
  v_mfma_f32_32x32x16_bf16 v[112:127], v[24:27], v[28:31], v[112:127]
  ds_read_b128 v[96:99], v12 offset:320
  ds_read_b128 v[100:103], v2 offset:320
  ds_read_b128 v[104:107], v12 offset:352
  ds_read_b128 v[108:111], v2 offset:352
  s_waitcnt lgkmcnt(14)
  v_mfma_f32_32x32x16_bf16 v[112:127], v[32:35], v[36:39], v[112:127]
  ds_read_b128 v[16:19], v12 offset:384
  ds_read_b128 v[20:23], v2 offset:384
  ds_read_b128 v[24:27], v12 offset:416
  ds_read_b128 v[28:31], v2 offset:416
  s_waitcnt lgkmcnt(14)
  v_mfma_f32_32x32x16_bf16 v[112:127], v[40:43], v[44:47], v[112:127]
  ds_read_b128 v[32:35], v12 offset:448
  ds_read_b128 v[36:39], v2 offset:448
  ds_read_b128 v[40:43], v12 offset:480
  ds_read_b128 v[44:47], v2 offset:480
  s_waitcnt lgkmcnt(14)
  v_mfma_f32_32x32x16_bf16 v[112:127], v[48:51], v[52:55], v[112:127]
  s_waitcnt lgkmcnt(0)
  v_mfma_f32_32x32x16_bf16 v[112:127], v[56:59], v[60:63], v[112:127]
  v_mfma_f32_32x32x16_bf16 v[112:127], v[64:67], v[68:71], v[112:127]
  v_mfma_f32_32x32x16_bf16 v[112:127], v[72:75], v[76:79], v[112:127]
  v_mfma_f32_32x32x16_bf16 v[112:127], v[80:83], v[84:87], v[112:127]
  v_mfma_f32_32x32x16_bf16 v[112:127], v[88:91], v[92:95], v[112:127]
  v_mfma_f32_32x32x16_bf16 v[112:127], v[96:99], v[100:103], v[112:127]
  v_mfma_f32_32x32x16_bf16 v[112:127], v[104:107], v[108:111], v[112:127]
  v_mfma_f32_32x32x16_bf16 v[112:127], v[16:19], v[20:23], v[112:127]
  v_mfma_f32_32x32x16_bf16 v[112:127], v[24:27], v[28:31], v[112:127]
  v_mfma_f32_32x32x16_bf16 v[112:127], v[32:35], v[36:39], v[112:127]
  s_barrier
  v_mfma_f32_32x32x16_bf16 v[112:127], v[40:43], v[44:47], v[112:127]
  s_nop 0
  s_lshl_b32 s21, s22, 6
  v_cmp_eq_u32 vcc, s21, v1
  v_lshlrev_b32 v11, 16, v11
  s_mul_i32 s30, s22, 0xaaaaaaaa
  v_cndmask_b32 v11, 0, v11, vcc
  s_mov_b32 s31, s30
  s_mul_i32 s23, s16, 4608
  s_lshl_b32 s29, s22, 11
  s_add_u32 s23, s23, s29
  s_add_u32 s23, s23, 10496
  v_lshl_add_u32 v24, v1, 4, s23
  v_add_f32 v112, v112, v11
  v_cndmask_b32 v116, v116, v117, s[30:31]
  v_cndmask_b32 v124, v124, v125, s[30:31]
  v_cvt_pk_bf16_f32 v16, v112, v113
  v_cvt_pk_bf16_f32 v17, v114, v115
  v_cvt_pk_bf16_f32 v18, v116, v117
  v_cvt_pk_bf16_f32 v19, v118, v119
  v_cvt_pk_bf16_f32 v20, v120, v121
  v_cvt_pk_bf16_f32 v21, v122, v123
  v_cvt_pk_bf16_f32 v22, v124, v125
  v_cvt_pk_bf16_f32 v23, v126, v127
  s_mul_i32 s21, s16, 9216
  s_add_u32 s21, s21, 768
  v_lshrrev_b32 v25, 5, v1
  v_and_b32 v25, s16, v25
  v_lshlrev_b32 v25, 12, v25
  v_lshl_add_u32 v25, v1, 4, v25
  v_add_u32 v25, s21, v25
  v_lshrrev_b32 v26, 2, v1
  v_lshrrev_b32 v27, 4, v1
  v_xor_b32 v26, v26, v27
  v_and_b32 v26, 1, v26
  v_lshlrev_b32 v26, 4, v26
  v_and_b32 v27, 3, v1
  v_lshl_add_u32 v26, v27, 5, v26
  v_lshrrev_b32 v27, 3, v1
  v_lshl_add_u32 v26, v27, 7, v26
  v_mov_b32 v8, 0
  v_mov_b32 v9, 1
  v_mov_b32 v27, 0
  s_lshl_b32 s20, s2, 7
  s_add_u32 s20, s20, 0xa06000
  s_and_b32 s21, s15, 3
  s_lshl_b32 s21, s21, 11
  s_lshl_b32 s29, s2, 13
  s_add_u32 s29, s29, s21
  s_add_u32 s29, s29, 0x604000
  s_add_u32 m0, s21, 1792
  s_barrier
  s_and_b32 s16, s15, 3
  s_lshr_b32 s17, s15, 2
  v_bfe_u32 v7, v1, 2, 3
  v_lshrrev_b32 v10, 5, v1
  v_add_u32 v7, v7, v10
  v_add_u32 v4, 3, v7
  v_bfe_u32 v4, v4, 1, 1
  v_xor_b32 v4, s17, v4
  v_lshlrev_b32 v4, 6, v4
  v_lshl_add_u32 v4, v7, 7, v4
  v_and_b32 v7, 3, v1
  v_lshl_add_u32 v4, v7, 4, v4
  s_lshl_b32 s35, s16, 10
  s_add_u32 s36, s35, 384
  v_add_u32 v5, s36, v4
  s_sub_u32 s36, 7552, s35
  v_add_u32 v4, s36, v4
  v_xor_b32 v13, 64, v4
  v_xor_b32 v14, 64, v5
  v_and_b32 v6, 16, v1
  v_lshlrev_b32 v6, 1, v6
  v_lshl_add_u32 v6, v7, 3, v6
  v_bfe_u32 v7, v1, 2, 2
  v_lshl_add_u32 v7, v10, 3, v7
  v_lshlrev_b32 v7, 3, v7
  v_sub_u32 v6, v6, v7
  s_mul_i32 s36, s17, 4608
  s_add_u32 s36, s36, 10528
  v_add_u32 v6, s36, v6
  v_mov_b32 v64, 0
  v_mov_b32 v65, 0
  v_mov_b32 v66, 0
  v_mov_b32 v67, 0
  v_mov_b32 v68, 0
  v_mov_b32 v69, 0
  v_mov_b32 v70, 0
  v_mov_b32 v71, 0
  v_mov_b32 v72, 0
  v_mov_b32 v73, 0
  v_mov_b32 v74, 0
  v_mov_b32 v75, 0
  v_mov_b32 v76, 0
  v_mov_b32 v77, 0
  v_mov_b32 v78, 0
  v_mov_b32 v79, 0
  v_mov_b32 v80, 0
  v_mov_b32 v81, 0
  v_mov_b32 v82, 0
  v_mov_b32 v83, 0
  v_mov_b32 v84, 0
  v_mov_b32 v85, 0
  v_mov_b32 v86, 0
  v_mov_b32 v87, 0
  v_mov_b32 v88, 0
  v_mov_b32 v89, 0
  v_mov_b32 v90, 0
  v_mov_b32 v91, 0
  v_mov_b32 v92, 0
  v_mov_b32 v93, 0
  v_mov_b32 v94, 0
  v_mov_b32 v95, 0
  s_barrier
  v_lshlrev_b32 v3, 4, v1
  s_and_b32 s88, s11, 3
  s_lshl2_add_u32 s88, s10, s88
  s_lshr_b32 s89, s11, 2
  s_and_b32 s90, s15, 3
  s_lshr_b32 s91, s15, 2
  s_lshl2_add_u32 s92, s89, s90
  s_lshl_b32 s92, s92, 16
  s_lshl_b32 s93, s88, 11
  s_add_u32 s92, s92, s93
  s_add_u32 s92, s92, 0x1000
  s_mul_i32 s93, s91, 66560
  s_add_u32 s93, s93, 27392
  v_and_b32 v7, 31, v1
  v_lshrrev_b32 v10, 5, v1
  v_add_u32 v0, s93, v3
  v_lshlrev_b32 v10, 8, v10
  v_lshl_add_u32 v10, v7, 4, v10
  v_add_u32 v10, 1024, v10
  v_and_b32 v11, 27, v7
  v_cmp_eq_u32 vcc, 16, v11
  v_mov_b32 v12, 2064
  v_mov_b32 v11, 2048
  v_cndmask_b32 v12, v12, v11, vcc
  v_cmp_gt_u32 vcc, 16, v7
  v_add_u32 v7, 512, v10
  v_mov_b32 v2, 0xdddddddd
  v_cndmask_b32 v11, v12, v10, vcc
  v_cndmask_b32 v12, v12, v7, vcc
  v_add_u32 v11, s93, v11
  v_add_u32 v12, s93, v12
  v_mov_b32 v96, 0
  v_mov_b32 v97, 0
  v_mov_b32 v98, 0
  v_mov_b32 v99, 0
  v_mov_b32 v100, 0
  v_mov_b32 v101, 0
  v_mov_b32 v102, 0
  v_mov_b32 v103, 0
  v_mov_b32 v104, 0
  v_mov_b32 v105, 0
  v_mov_b32 v106, 0
  v_mov_b32 v107, 0
  v_mov_b32 v108, 0
  v_mov_b32 v109, 0
  v_mov_b32 v110, 0
  v_mov_b32 v111, 0
  v_mov_b32 v112, 0
  v_mov_b32 v113, 0
  v_mov_b32 v114, 0
  v_mov_b32 v115, 0
  v_mov_b32 v116, 0
  v_mov_b32 v117, 0
  v_mov_b32 v118, 0
  v_mov_b32 v119, 0
  v_mov_b32 v120, 0
  v_mov_b32 v121, 0
  v_mov_b32 v122, 0
  v_mov_b32 v123, 0
  v_mov_b32 v124, 0
  v_mov_b32 v125, 0
  v_mov_b32 v126, 0
  v_mov_b32 v127, 0
  s_mov_b64 exec, 1
  buffer_atomic_or v27, v8, s[24:27], s20 offen sc0 sc1
  s_mov_b64 exec, -1
  s_barrier
  s_waitcnt vmcnt(0)
  v_readfirstlane_b32 s21, v27
  s_nop 0
  s_cmp_eq_u32 s21, -1
  s_cbranch_scc1 F_ku
  s_mov_b32 s33, 0
KW25:
  s_mov_b64 exec, 1
  v_mov_b32 v27, 0
  buffer_atomic_or v27, v8, s[24:27], s20 offen sc0 sc1
  s_waitcnt vmcnt(0)
  v_readfirstlane_b32 s21, v27
  s_mov_b64 exec, -1
  s_andn2_b32 s34, -1, s21
  s_cbranch_scc0 KD26
  s_add_u32 s33, s33, 1
  s_cmp_lt_u32 s33, 0x30d40
  s_cbranch_scc1 KW25
  s_mov_b32 s21, -1
KD26:
F_ku:
  buffer_load_dwordx4 v26, s[24:27], s29 offen sc1 lds
  buffer_load_dwordx4 v26, s[24:27], s29 offen offset:1024 sc1 lds
  s_waitcnt vmcnt(0)
  ds_write_b128 v25, v[64:67]
  ds_write_b128 v24, v[16:19]
  ds_write_b128 v24, v[20:23] offset:1024
  s_mov_b64 exec, 1
  ds_add_u32 v8, v9 offset:52
  s_mov_b64 exec, -1
  s_branch F_conv
F_gemm:
  v_and_b32 v18, 15, v1
  v_lshrrev_b32 v19, 4, v1
  v_lshrrev_b32 v23, 2, v18
  v_and_b32 v24, 3, v1
  v_lshl_add_u32 v25, v23, 3, v24
  v_lshrrev_b32 v26, 1, v24
  v_lshl_or_b32 v26, v23, 1, v26
  v_xor_b32 v26, v26, v19
  v_lshlrev_b32 v26, 4, v26
  v_lshl_add_u32 v72, v25, 7, v26
  v_add_u32 v72, 32768, v72
  v_xor_b32 v73, 64, v72
  v_lshl_add_u32 v26, v19, 3, v23
  v_lshlrev_b32 v26, 7, v26
  v_lshrrev_b32 v27, 1, v23
  v_and_b32 v28, 1, v19
  v_lshl_or_b32 v27, v28, 1, v27
  v_xor_b32 v27, s15, v27
  v_lshl_add_u32 v26, v27, 5, v26
  v_lshl_add_u32 v26, v24, 3, v26
  v_add_u32 v74, 40960, v26
  v_lshl_add_u32 v25, v28, 2, v25
  v_and_b32 v26, 32, v1
  v_add_lshl_u32 v75, v25, v26, 4
  v_mov_b32 v80, 0
  v_mov_b32 v81, 0
  v_mov_b32 v82, 0
  v_mov_b32 v83, 0
  v_mov_b32 v84, 0
  v_mov_b32 v85, 0
  v_mov_b32 v86, 0
  v_mov_b32 v87, 0
  v_mov_b32 v88, 0
  v_mov_b32 v89, 0
  v_mov_b32 v90, 0
  v_mov_b32 v91, 0
  v_mov_b32 v92, 0
  v_mov_b32 v93, 0
  v_mov_b32 v94, 0
  v_mov_b32 v95, 0
  v_mov_b32 v96, 0
  v_mov_b32 v97, 0
  v_mov_b32 v98, 0
  v_mov_b32 v99, 0
  v_mov_b32 v100, 0
  v_mov_b32 v101, 0
  v_mov_b32 v102, 0
  v_mov_b32 v103, 0
  v_mov_b32 v104, 0
  v_mov_b32 v105, 0
  v_mov_b32 v106, 0
  v_mov_b32 v107, 0
  v_mov_b32 v108, 0
  v_mov_b32 v109, 0
  v_mov_b32 v110, 0
  v_mov_b32 v111, 0
  v_mov_b32 v112, 0
  v_mov_b32 v113, 0
  v_mov_b32 v114, 0
  v_mov_b32 v115, 0
  v_mov_b32 v116, 0
  v_mov_b32 v117, 0
  v_mov_b32 v118, 0
  v_mov_b32 v119, 0
  v_mov_b32 v120, 0
  v_mov_b32 v121, 0
  v_mov_b32 v122, 0
  v_mov_b32 v123, 0
  v_mov_b32 v124, 0
  v_mov_b32 v125, 0
  v_mov_b32 v126, 0
  v_mov_b32 v127, 0
  s_lshl2_add_u32 s33, s13, s15
  s_lshl_b32 s40, s33, 10
  s_lshl_b32 s32, s33, 12
  s_lshl_b32 s38, s12, 17
  s_add_u32 s32, s32, s38
  s_lshl_b32 s33, s33, 11
  s_lshl_b32 s38, s12, 16
  s_add_u32 s33, s33, s38
  s_add_u32 s33, s33, 0x1000
  s_add_u32 s32, s32, 0x202000
  s_mov_b32 s38, 0x3eb8aa3b
  s_mov_b32 s39, 0x3eb8aa3b
  s_add_u32 s40, s40, 0xa06004
  s_and_b32 s41, s12, 3
  s_lshr_b32 s42, s12, 2
  s_lshl3_add_u32 s41, s41, s42
  s_mov_b32 s36, 4
  s_mul_i32 s19, s16, 130304
  s_add_u32 s19, s19, 768
  s_bfe_u32 s22, s15, 0x10001
  s_mul_i32 s30, s22, 0x4338aa3b
  s_mul_i32 s31, s22, 0x41a2f983
  s_mul_i32 s29, s22, 8448
  s_add_u32 s29, s29, s19
  v_lshl_add_u32 v13, v1, 3, s29
  s_mov_b32 s21, 3
  s_waitcnt vmcnt(0)
  v_lshlrev_b32 v14, 16, v10
  v_mul_f32 v14, 0x3fb8aa3b, v14
  v_exp_f32 v14, v14
  v_lshlrev_b32 v16, 16, v4
  v_and_b32 v17, 0xffff0000, v4
  v_cvt_pk_bf16_f32 v14, v14, v14
  v_lshlrev_b32 v18, 16, v5
  v_and_b32 v19, 0xffff0000, v5
  v_and_b32 v14, 0xffff0000, v14
  v_mul_f32 v16, v14, v16
  v_mul_f32 v17, v14, v17
  v_mul_f32 v18, v14, v18
  v_mul_f32 v19, v14, v19
  v_mul_f32 v48, 0x4138aa3b, v16
  v_mul_f32 v56, 0x3fa2f983, v18
  v_mul_f32 v49, 0x4138aa3b, v17
  v_mul_f32 v57, 0x3fa2f983, v19
  v_mul_f32 v50, s30, v16
  v_mul_f32 v58, s31, v18
  v_mul_f32 v51, s30, v17
  v_mul_f32 v59, s31, v19
  v_exp_f32 v48, v48
  v_fract_f32 v56, v56
  v_exp_f32 v49, v49
  v_fract_f32 v57, v57
  v_exp_f32 v50, v50
  v_fract_f32 v58, v58
  v_exp_f32 v51, v51
  v_fract_f32 v59, v59
  v_cos_f32 v20, v56
  v_sin_f32 v21, v56
  v_cos_f32 v22, v57
  v_sin_f32 v23, v57
  v_cos_f32 v24, v58
  v_sin_f32 v25, v58
  v_cos_f32 v26, v59
  v_sin_f32 v27, v59
  v_mul_f32 v20, v48, v20
  v_mul_f32 v21, v48, v21
  v_mul_f32 v22, v49, v22
  v_mul_f32 v23, v49, v23
  v_mul_f32 v24, v50, v24
  v_mul_f32 v25, v50, v25
  v_mul_f32 v26, v51, v26
  v_mul_f32 v27, v51, v27
.p2align 3
F_ky:
  s_sub_u32 s21, s21, 1
  s_nop 0
  v_cvt_pk_bf16_f32 v44, v24, v25
  v_cvt_pk_bf16_f32 v45, v26, v27
  ds_write_b64 v13, v[44:45] offset:0
  v_pk_mul_f32 v[48:49], v[24:25], v[20:21] op_sel:[0,0] op_sel_hi:[1,0]
  v_pk_mul_f32 v[50:51], v[26:27], v[22:23] op_sel:[0,0] op_sel_hi:[1,0]
  v_pk_fma_f32 v[24:25], v[24:25], v[20:21], v[48:49] op_sel:[1,1,0] op_sel_hi:[0,1,1] neg_lo:[1,0,0]
  v_pk_fma_f32 v[26:27], v[26:27], v[22:23], v[50:51] op_sel:[1,1,0] op_sel_hi:[0,1,1] neg_lo:[1,0,0]
  v_cvt_pk_bf16_f32 v46, v24, v25
  v_cvt_pk_bf16_f32 v47, v26, v27
  ds_write_b64 v13, v[46:47] offset:528
  v_pk_mul_f32 v[48:49], v[24:25], v[20:21] op_sel:[0,0] op_sel_hi:[1,0]
  v_pk_mul_f32 v[50:51], v[26:27], v[22:23] op_sel:[0,0] op_sel_hi:[1,0]
  v_pk_fma_f32 v[24:25], v[24:25], v[20:21], v[48:49] op_sel:[1,1,0] op_sel_hi:[0,1,1] neg_lo:[1,0,0]
  v_pk_fma_f32 v[26:27], v[26:27], v[22:23], v[50:51] op_sel:[1,1,0] op_sel_hi:[0,1,1] neg_lo:[1,0,0]
  v_cvt_pk_bf16_f32 v44, v24, v25
  v_cvt_pk_bf16_f32 v45, v26, v27
  ds_write_b64 v13, v[44:45] offset:1056
  v_pk_mul_f32 v[48:49], v[24:25], v[20:21] op_sel:[0,0] op_sel_hi:[1,0]
  v_pk_mul_f32 v[50:51], v[26:27], v[22:23] op_sel:[0,0] op_sel_hi:[1,0]
  v_pk_fma_f32 v[24:25], v[24:25], v[20:21], v[48:49] op_sel:[1,1,0] op_sel_hi:[0,1,1] neg_lo:[1,0,0]
  v_pk_fma_f32 v[26:27], v[26:27], v[22:23], v[50:51] op_sel:[1,1,0] op_sel_hi:[0,1,1] neg_lo:[1,0,0]
  v_cvt_pk_bf16_f32 v46, v24, v25
  v_cvt_pk_bf16_f32 v47, v26, v27
  ds_write_b64 v13, v[46:47] offset:1584
  v_pk_mul_f32 v[48:49], v[24:25], v[20:21] op_sel:[0,0] op_sel_hi:[1,0]
  v_pk_mul_f32 v[50:51], v[26:27], v[22:23] op_sel:[0,0] op_sel_hi:[1,0]
  v_pk_fma_f32 v[24:25], v[24:25], v[20:21], v[48:49] op_sel:[1,1,0] op_sel_hi:[0,1,1] neg_lo:[1,0,0]
  v_pk_fma_f32 v[26:27], v[26:27], v[22:23], v[50:51] op_sel:[1,1,0] op_sel_hi:[0,1,1] neg_lo:[1,0,0]
  v_add_u32 v13, 2112, v13
  s_cbranch_scc0 F_ky
  s_waitcnt lgkmcnt(0)
  s_barrier
  s_setprio 2
  v_lshlrev_b32 v3, 4, v1
  v_mov_b32 v8, 0
  v_mov_b32 v9, 1
  v_mov_b32 v2, 0
  s_mov_b32 s35, 0
MW27:
  ds_read_b128 v[4:7], v2 offset:576
  s_waitcnt lgkmcnt(0)
  v_min3_u32 v4, v4, v5, v6
  v_min_u32 v4, v4, v7
  s_add_u32 s35, s35, 1
  v_readfirstlane_b32 s34, v4
  s_nop 0
  s_cmp_lg_u32 s34, 0
  s_cbranch_scc1 MD28
  s_sleep 1
  s_cmp_lt_u32 s35, 0x186a00
  s_cbranch_scc1 MW27
MD28:
  ds_read_b64_tr_b16 v[36:37], v74 offset:8192
  ds_read_b64_tr_b16 v[38:39], v74 offset:8704
  ds_read_b64_tr_b16 v[40:41], v74 offset:16384
  ds_read_b64_tr_b16 v[42:43], v74 offset:16896
  ds_read_b128 v[16:19], v72 offset:0
  ds_read_b128 v[20:23], v72 offset:512
  ds_read_b128 v[24:27], v72 offset:4096
  ds_read_b128 v[28:31], v72 offset:4608
  ds_read_b64_tr_b16 v[32:33], v74 offset:0
  ds_read_b64_tr_b16 v[34:35], v74 offset:512
  ds_read_b128 v[4:7], v2 offset:592
  s_branch F_gl1
F_gw0:
  s_mov_b32 s35, 0
MW29:
  ds_read_b128 v[4:7], v2 offset:576
  s_waitcnt lgkmcnt(0)
  v_min3_u32 v4, v4, v5, v6
  v_min_u32 v4, v4, v7
  s_add_u32 s35, s35, 1
  v_readfirstlane_b32 s34, v4
  s_nop 0
  s_cmp_lg_u32 s34, 0
  s_cbranch_scc1 MD30
  s_cmp_lt_u32 s35, 0x186a00
  s_cbranch_scc1 MW29
MD30:
  s_branch F_gc0
F_gw1:
  s_mov_b32 s35, 0
MW31:
  ds_read_b128 v[4:7], v2 offset:592
  s_waitcnt lgkmcnt(0)
  v_min3_u32 v4, v4, v5, v6
  v_min_u32 v4, v4, v7
  s_add_u32 s35, s35, 1
  v_readfirstlane_b32 s34, v4
  s_nop 0
  s_cmp_lg_u32 s34, 0
  s_cbranch_scc1 MD32
  s_cmp_lt_u32 s35, 0x186a00
  s_cbranch_scc1 MW31
MD32:
  s_branch F_gc1
.p2align 3
F_gl:
  s_cmp_eq_u32 s37, 0
  s_waitcnt lgkmcnt(0)
  s_nop 0
  s_cbranch_scc1 F_gw0
F_gc0:
  ds_read_b64_tr_b16 v[36:37], v74 offset:8192
  ds_read_b64_tr_b16 v[38:39], v74 offset:8704
  v_mfma_f32_16x16x32_bf16 v[96:99], v[64:67], v[44:47], v[96:99]
  ds_read_b64_tr_b16 v[40:41], v74 offset:16384
  ds_read_b64_tr_b16 v[42:43], v74 offset:16896
  v_mfma_f32_16x16x32_bf16 v[100:103], v[64:67], v[48:51], v[100:103]
  ds_read_b128 v[16:19], v72 offset:0
  ds_read_b128 v[20:23], v72 offset:512
  v_mfma_f32_16x16x32_bf16 v[104:107], v[64:67], v[52:55], v[104:107]
  ds_read_b128 v[24:27], v72 offset:4096
  ds_read_b128 v[28:31], v72 offset:4608
  v_mfma_f32_16x16x32_bf16 v[108:111], v[64:67], v[56:59], v[108:111]
  ds_read_b64_tr_b16 v[32:33], v74 offset:0
  ds_read_b64_tr_b16 v[34:35], v74 offset:512
  v_mfma_f32_16x16x32_bf16 v[112:115], v[44:47], v[68:71], v[112:115]
  ds_read_b128 v[4:7], v2 offset:592
  v_mfma_f32_16x16x32_bf16 v[116:119], v[48:51], v[68:71], v[116:119]
  v_mfma_f32_16x16x32_bf16 v[120:123], v[52:55], v[68:71], v[120:123]
  v_mfma_f32_16x16x32_bf16 v[124:127], v[56:59], v[68:71], v[124:127]
  v_mfma_f32_16x16x32_bf16 v[80:83], v[60:63], v[44:47], v[80:83]
  v_mfma_f32_16x16x32_bf16 v[84:87], v[60:63], v[48:51], v[84:87]
  v_mfma_f32_16x16x32_bf16 v[88:91], v[60:63], v[52:55], v[88:91]
  v_mfma_f32_16x16x32_bf16 v[92:95], v[60:63], v[56:59], v[92:95]
F_gl1:
  s_waitcnt lgkmcnt(0)
  s_sub_u32 s36, s36, 1
  ds_read_b64_tr_b16 v[64:65], v74 offset:12288
  ds_read_b64_tr_b16 v[66:67], v74 offset:12800
  v_mfma_f32_16x16x32_bf16 v[96:99], v[36:39], v[16:19], v[96:99]
  ds_read_b64_tr_b16 v[68:69], v74 offset:20480
  ds_read_b64_tr_b16 v[70:71], v74 offset:20992
  v_mfma_f32_16x16x32_bf16 v[100:103], v[36:39], v[20:23], v[100:103]
  ds_read_b128 v[44:47], v73 offset:0
  ds_read_b128 v[48:51], v73 offset:512
  v_mfma_f32_16x16x32_bf16 v[104:107], v[36:39], v[24:27], v[104:107]
  ds_read_b128 v[52:55], v73 offset:4096
  ds_read_b128 v[56:59], v73 offset:4608
  v_mfma_f32_16x16x32_bf16 v[108:111], v[36:39], v[28:31], v[108:111]
  ds_read_b64_tr_b16 v[60:61], v74 offset:4096
  ds_read_b64_tr_b16 v[62:63], v74 offset:4608
  v_mfma_f32_16x16x32_bf16 v[112:115], v[16:19], v[40:43], v[112:115]
  v_min3_u32 v4, v4, v5, v6
  v_mfma_f32_16x16x32_bf16 v[116:119], v[20:23], v[40:43], v[116:119]
  v_min_u32 v4, v4, v7
  s_nop 0
  v_mfma_f32_16x16x32_bf16 v[120:123], v[24:27], v[40:43], v[120:123]
  v_readfirstlane_b32 s37, v4
  s_nop 0
  v_mfma_f32_16x16x32_bf16 v[124:127], v[28:31], v[40:43], v[124:127]
  v_mfma_f32_16x16x32_bf16 v[80:83], v[32:35], v[16:19], v[80:83]
  v_mfma_f32_16x16x32_bf16 v[84:87], v[32:35], v[20:23], v[84:87]
  v_mfma_f32_16x16x32_bf16 v[88:91], v[32:35], v[24:27], v[88:91]
  v_mfma_f32_16x16x32_bf16 v[92:95], v[32:35], v[28:31], v[92:95]
  s_cmp_eq_u32 s37, 0
  s_waitcnt lgkmcnt(0)
  s_barrier
  s_cbranch_scc1 F_gw1
F_gc1:
  ds_read_b64_tr_b16 v[36:37], v74 offset:40960
  ds_read_b64_tr_b16 v[38:39], v74 offset:41472
  v_mfma_f32_16x16x32_bf16 v[96:99], v[64:67], v[44:47], v[96:99]
  ds_read_b64_tr_b16 v[40:41], v74 offset:49152
  ds_read_b64_tr_b16 v[42:43], v74 offset:49664
  v_mfma_f32_16x16x32_bf16 v[100:103], v[64:67], v[48:51], v[100:103]
  ds_read_b128 v[16:19], v72 offset:32768
  ds_read_b128 v[20:23], v72 offset:33280
  v_mfma_f32_16x16x32_bf16 v[104:107], v[64:67], v[52:55], v[104:107]
  ds_read_b128 v[24:27], v72 offset:36864
  ds_read_b128 v[28:31], v72 offset:37376
  v_mfma_f32_16x16x32_bf16 v[108:111], v[64:67], v[56:59], v[108:111]
  ds_read_b64_tr_b16 v[32:33], v74 offset:32768
  ds_read_b64_tr_b16 v[34:35], v74 offset:33280
  v_mfma_f32_16x16x32_bf16 v[112:115], v[44:47], v[68:71], v[112:115]
  ds_read_b128 v[4:7], v2 offset:608
  v_mfma_f32_16x16x32_bf16 v[116:119], v[48:51], v[68:71], v[116:119]
  v_mfma_f32_16x16x32_bf16 v[120:123], v[52:55], v[68:71], v[120:123]
  v_mfma_f32_16x16x32_bf16 v[124:127], v[56:59], v[68:71], v[124:127]
  v_mfma_f32_16x16x32_bf16 v[80:83], v[60:63], v[44:47], v[80:83]
  v_mfma_f32_16x16x32_bf16 v[84:87], v[60:63], v[48:51], v[84:87]
  v_mfma_f32_16x16x32_bf16 v[88:91], v[60:63], v[52:55], v[88:91]
  v_mfma_f32_16x16x32_bf16 v[92:95], v[60:63], v[56:59], v[92:95]
  s_waitcnt lgkmcnt(0)
  s_cmp_lg_u32 s36, 0
  ds_read_b64_tr_b16 v[64:65], v74 offset:45056
  ds_read_b64_tr_b16 v[66:67], v74 offset:45568
  v_mfma_f32_16x16x32_bf16 v[96:99], v[36:39], v[16:19], v[96:99]
  ds_read_b64_tr_b16 v[68:69], v74 offset:53248
  ds_read_b64_tr_b16 v[70:71], v74 offset:53760
  v_mfma_f32_16x16x32_bf16 v[100:103], v[36:39], v[20:23], v[100:103]
  ds_read_b128 v[44:47], v73 offset:32768
  ds_read_b128 v[48:51], v73 offset:33280
  v_mfma_f32_16x16x32_bf16 v[104:107], v[36:39], v[24:27], v[104:107]
  ds_read_b128 v[52:55], v73 offset:36864
  ds_read_b128 v[56:59], v73 offset:37376
  v_mfma_f32_16x16x32_bf16 v[108:111], v[36:39], v[28:31], v[108:111]
  ds_read_b64_tr_b16 v[60:61], v74 offset:36864
  ds_read_b64_tr_b16 v[62:63], v74 offset:37376
  v_mfma_f32_16x16x32_bf16 v[112:115], v[16:19], v[40:43], v[112:115]
  v_min3_u32 v4, v4, v5, v6
  v_mfma_f32_16x16x32_bf16 v[116:119], v[20:23], v[40:43], v[116:119]
  v_min_u32 v4, v4, v7
  s_nop 0
  v_mfma_f32_16x16x32_bf16 v[120:123], v[24:27], v[40:43], v[120:123]
  v_readfirstlane_b32 s37, v4
  s_nop 0
  v_mfma_f32_16x16x32_bf16 v[124:127], v[28:31], v[40:43], v[124:127]
  v_xor_b32 v72, 0x10000, v72
  v_mfma_f32_16x16x32_bf16 v[80:83], v[32:35], v[16:19], v[80:83]
  v_xor_b32 v73, 0x10000, v73
  v_mfma_f32_16x16x32_bf16 v[84:87], v[32:35], v[20:23], v[84:87]
  v_xor_b32 v74, 0x10000, v74
  v_mfma_f32_16x16x32_bf16 v[88:91], v[32:35], v[24:27], v[88:91]
  v_add_u32 v2, 32, v2
  s_nop 0
  v_mfma_f32_16x16x32_bf16 v[92:95], v[32:35], v[28:31], v[92:95]
  s_cbranch_scc1 F_gl
  s_waitcnt lgkmcnt(0)
  v_mfma_f32_16x16x32_bf16 v[80:83], v[60:63], v[44:47], v[80:83]
  v_mfma_f32_16x16x32_bf16 v[84:87], v[60:63], v[48:51], v[84:87]
  v_mfma_f32_16x16x32_bf16 v[88:91], v[60:63], v[52:55], v[88:91]
  v_mfma_f32_16x16x32_bf16 v[92:95], v[60:63], v[56:59], v[92:95]
  v_mfma_f32_16x16x32_bf16 v[96:99], v[64:67], v[44:47], v[96:99]
  v_mfma_f32_16x16x32_bf16 v[100:103], v[64:67], v[48:51], v[100:103]
  v_mfma_f32_16x16x32_bf16 v[104:107], v[64:67], v[52:55], v[104:107]
  v_mfma_f32_16x16x32_bf16 v[108:111], v[64:67], v[56:59], v[108:111]
  v_mfma_f32_16x16x32_bf16 v[112:115], v[44:47], v[68:71], v[112:115]
  v_mul_f32 v80, s38, v80
  v_mul_f32 v81, s38, v81
  v_mfma_f32_16x16x32_bf16 v[116:119], v[48:51], v[68:71], v[116:119]
  v_mul_f32 v82, s38, v82
  v_mul_f32 v83, s38, v83
  v_mfma_f32_16x16x32_bf16 v[120:123], v[52:55], v[68:71], v[120:123]
  v_mul_f32 v84, s38, v84
  v_mul_f32 v85, s38, v85
  v_mfma_f32_16x16x32_bf16 v[124:127], v[56:59], v[68:71], v[124:127]
  v_mul_f32 v86, s38, v86
  v_mul_f32 v87, s38, v87
  v_cvt_pk_bf16_f32 v16, v96, v97
  v_cvt_pk_bf16_f32 v17, v98, v99
  v_cvt_pk_bf16_f32 v18, v100, v101
  v_cvt_pk_bf16_f32 v19, v102, v103
  v_cvt_pk_bf16_f32 v20, v104, v105
  v_cvt_pk_bf16_f32 v21, v106, v107
  v_cvt_pk_bf16_f32 v22, v108, v109
  v_cvt_pk_bf16_f32 v23, v110, v111
  v_mul_f32 v88, s38, v88
  v_permlane16_swap_b32 v16, v18
  v_permlane16_swap_b32 v17, v19
  v_permlane16_swap_b32 v20, v22
  v_permlane16_swap_b32 v21, v23
  buffer_store_dwordx4 v[16:19], v75, s[24:27], s32 offen offset:0 sc1
  buffer_store_dwordx4 v[20:23], v75, s[24:27], s32 offen offset:2048 sc1
  v_cvt_pk_bf16_f32 v24, v112, v113
  v_cvt_pk_bf16_f32 v25, v114, v115
  v_cvt_pk_bf16_f32 v26, v116, v117
  v_cvt_pk_bf16_f32 v27, v118, v119
  v_cvt_pk_bf16_f32 v28, v120, v121
  v_cvt_pk_bf16_f32 v29, v122, v123
  v_cvt_pk_bf16_f32 v30, v124, v125
  v_cvt_pk_bf16_f32 v31, v126, v127
  buffer_store_dwordx4 v[24:27], v3, s[24:27], s32 offen offset:1024 sc1
  buffer_store_dwordx4 v[28:31], v3, s[24:27], s32 offen offset:3072 sc1
  v_mul_f32 v89, s38, v89
  v_mul_f32 v90, s38, v90
  v_mul_f32 v91, s38, v91
  v_mul_f32 v92, s38, v92
  v_mul_f32 v93, s38, v93
  v_mul_f32 v94, s38, v94
  v_mul_f32 v95, s38, v95
  v_cvt_pk_bf16_f32 v32, v80, v81
  v_cvt_pk_bf16_f32 v33, v82, v83
  v_cvt_pk_bf16_f32 v34, v84, v85
  v_cvt_pk_bf16_f32 v35, v86, v87
  v_cvt_pk_bf16_f32 v36, v88, v89
  v_cvt_pk_bf16_f32 v37, v90, v91
  v_cvt_pk_bf16_f32 v38, v92, v93
  v_cvt_pk_bf16_f32 v39, v94, v95
  s_nop 0
  v_permlane16_swap_b32 v32, v34
  v_permlane16_swap_b32 v33, v35
  v_permlane16_swap_b32 v36, v38
  v_permlane16_swap_b32 v37, v39
  buffer_store_dwordx4 v[32:35], v75, s[24:27], s33 offen offset:0 sc1
  buffer_store_dwordx4 v[36:39], v75, s[24:27], s33 offen offset:1024 sc1
  s_mov_b64 exec, 1
  ds_add_u32 v8, v9 offset:96
  s_mov_b64 exec, -1
  s_and_b32 s16, s15, 3
  s_lshr_b32 s17, s15, 2
  v_bfe_u32 v7, v1, 2, 3
  v_lshrrev_b32 v10, 5, v1
  v_add_u32 v7, v7, v10
  v_add_u32 v4, 3, v7
  v_bfe_u32 v4, v4, 1, 1
  v_xor_b32 v4, s17, v4
  v_lshlrev_b32 v4, 6, v4
  v_lshl_add_u32 v4, v7, 7, v4
  v_and_b32 v7, 3, v1
  v_lshl_add_u32 v4, v7, 4, v4
  s_lshl_b32 s35, s16, 10
  s_add_u32 s36, s35, 384
  v_add_u32 v5, s36, v4
  s_sub_u32 s36, 7552, s35
  v_add_u32 v4, s36, v4
  v_xor_b32 v13, 64, v4
  v_xor_b32 v14, 64, v5
  v_and_b32 v6, 16, v1
  v_lshlrev_b32 v6, 1, v6
  v_lshl_add_u32 v6, v7, 3, v6
  v_bfe_u32 v7, v1, 2, 2
  v_lshl_add_u32 v7, v10, 3, v7
  v_lshlrev_b32 v7, 3, v7
  v_sub_u32 v6, v6, v7
  s_mul_i32 s36, s17, 4608
  s_add_u32 s36, s36, 10528
  v_add_u32 v6, s36, v6
  v_mov_b32 v64, 0
  v_mov_b32 v65, 0
  v_mov_b32 v66, 0
  v_mov_b32 v67, 0
  v_mov_b32 v68, 0
  v_mov_b32 v69, 0
  v_mov_b32 v70, 0
  v_mov_b32 v71, 0
  v_mov_b32 v72, 0
  v_mov_b32 v73, 0
  v_mov_b32 v74, 0
  v_mov_b32 v75, 0
  v_mov_b32 v76, 0
  v_mov_b32 v77, 0
  v_mov_b32 v78, 0
  v_mov_b32 v79, 0
  v_mov_b32 v80, 0
  v_mov_b32 v81, 0
  v_mov_b32 v82, 0
  v_mov_b32 v83, 0
  v_mov_b32 v84, 0
  v_mov_b32 v85, 0
  v_mov_b32 v86, 0
  v_mov_b32 v87, 0
  v_mov_b32 v88, 0
  v_mov_b32 v89, 0
  v_mov_b32 v90, 0
  v_mov_b32 v91, 0
  v_mov_b32 v92, 0
  v_mov_b32 v93, 0
  v_mov_b32 v94, 0
  v_mov_b32 v95, 0
  v_lshlrev_b32 v3, 4, v1
  s_and_b32 s88, s11, 3
  s_lshl2_add_u32 s88, s10, s88
  s_lshr_b32 s89, s11, 2
  s_and_b32 s90, s15, 3
  s_lshr_b32 s91, s15, 2
  s_lshl2_add_u32 s92, s89, s90
  s_lshl_b32 s92, s92, 16
  s_lshl_b32 s93, s88, 11
  s_add_u32 s92, s92, s93
  s_add_u32 s92, s92, 0x1000
  s_mul_i32 s93, s91, 66560
  s_add_u32 s93, s93, 27392
  v_and_b32 v7, 31, v1
  v_lshrrev_b32 v10, 5, v1
  v_add_u32 v0, s93, v3
  v_lshlrev_b32 v10, 8, v10
  v_lshl_add_u32 v10, v7, 4, v10
  v_add_u32 v10, 1024, v10
  v_and_b32 v11, 27, v7
  v_cmp_eq_u32 vcc, 16, v11
  v_mov_b32 v12, 2064
  v_mov_b32 v11, 2048
  v_cndmask_b32 v12, v12, v11, vcc
  v_cmp_gt_u32 vcc, 16, v7
  v_add_u32 v7, 512, v10
  v_mov_b32 v2, 0xdddddddd
  v_cndmask_b32 v11, v12, v10, vcc
  v_cndmask_b32 v12, v12, v7, vcc
  v_add_u32 v11, s93, v11
  v_add_u32 v12, s93, v12
  v_mov_b32 v96, 0
  v_mov_b32 v97, 0
  v_mov_b32 v98, 0
  v_mov_b32 v99, 0
  v_mov_b32 v100, 0
  v_mov_b32 v101, 0
  v_mov_b32 v102, 0
  v_mov_b32 v103, 0
  v_mov_b32 v104, 0
  v_mov_b32 v105, 0
  v_mov_b32 v106, 0
  v_mov_b32 v107, 0
  v_mov_b32 v108, 0
  v_mov_b32 v109, 0
  v_mov_b32 v110, 0
  v_mov_b32 v111, 0
  v_mov_b32 v112, 0
  v_mov_b32 v113, 0
  v_mov_b32 v114, 0
  v_mov_b32 v115, 0
  v_mov_b32 v116, 0
  v_mov_b32 v117, 0
  v_mov_b32 v118, 0
  v_mov_b32 v119, 0
  v_mov_b32 v120, 0
  v_mov_b32 v121, 0
  v_mov_b32 v122, 0
  v_mov_b32 v123, 0
  v_mov_b32 v124, 0
  v_mov_b32 v125, 0
  v_mov_b32 v126, 0
  v_mov_b32 v127, 0
  v_lshlrev_b32 v7, 7, v1
  v_lshlrev_b32 v10, s41, v9
  s_waitcnt vmcnt(0)
  s_mov_b64 exec, 0xff
  buffer_atomic_or v10, v7, s[24:27], s40 offen sc1
  s_mov_b64 exec, -1
F_conv:
  s_add_u32 s30, s16, 1
  s_mov_b32 s34, 0
LW33:
  ds_read_b32 v10, v8 offset:52
  s_waitcnt lgkmcnt(0)
  v_readfirstlane_b32 s33, v10
  s_add_u32 s34, s34, 1
  s_cmp_ge_u32 s33, 4
  s_cbranch_scc1 LD34
  s_sleep 1
  s_cmp_lt_u32 s34, 0x186a00
  s_cbranch_scc1 LW33
LD34:
  s_setprio 2
  ds_read_b64_tr_b16 v[16:17], v6 offset:32
  ds_read_b64_tr_b16 v[18:19], v6 offset:0
  ds_read_b128 v[20:23], v4 offset:1280
  ds_read_b128 v[24:27], v5 offset:1280
  ds_read_b64_tr_b16 v[28:29], v6 offset:160
  ds_read_b64_tr_b16 v[30:31], v6 offset:128
  ds_read_b128 v[32:35], v13 offset:1024
  ds_read_b128 v[36:39], v14 offset:1024
F_c1:
  s_sub_u32 s30, s30, 1
  s_cmp_lg_u32 s30, 0
  ds_read_b64_tr_b16 v[40:41], v6 offset:288
  ds_read_b64_tr_b16 v[42:43], v6 offset:256
  ds_read_b128 v[44:47], v4 offset:768
  ds_read_b128 v[48:51], v5 offset:768
  s_waitcnt lgkmcnt(8)
  v_mfma_f32_32x32x16_bf16 v[64:79], v[20:23], v[16:19], v[64:79]
  v_mfma_f32_32x32x16_bf16 v[80:95], v[24:27], v[16:19], v[80:95]
  ds_read_b64_tr_b16 v[52:53], v6 offset:416
  ds_read_b64_tr_b16 v[54:55], v6 offset:384
  ds_read_b128 v[56:59], v13 offset:512
  ds_read_b128 v[60:63], v14 offset:512
  s_waitcnt lgkmcnt(8)
  v_mfma_f32_32x32x16_bf16 v[64:79], v[32:35], v[28:31], v[64:79]
  v_mfma_f32_32x32x16_bf16 v[80:95], v[36:39], v[28:31], v[80:95]
  ds_read_b64_tr_b16 v[16:17], v6 offset:544
  ds_read_b64_tr_b16 v[18:19], v6 offset:512
  ds_read_b128 v[20:23], v4 offset:256
  ds_read_b128 v[24:27], v5 offset:256
  s_waitcnt lgkmcnt(8)
  v_mfma_f32_32x32x16_bf16 v[64:79], v[44:47], v[40:43], v[64:79]
  v_mfma_f32_32x32x16_bf16 v[80:95], v[48:51], v[40:43], v[80:95]
  ds_read_b64_tr_b16 v[28:29], v6 offset:672
  ds_read_b64_tr_b16 v[30:31], v6 offset:640
  ds_read_b128 v[32:35], v13 offset:0
  ds_read_b128 v[36:39], v14 offset:0
  s_waitcnt lgkmcnt(8)
  v_mfma_f32_32x32x16_bf16 v[64:79], v[56:59], v[52:55], v[64:79]
  v_mfma_f32_32x32x16_bf16 v[80:95], v[60:63], v[52:55], v[80:95]
  v_add_u32 v6, 512, v6
  v_subrev_u32 v4, 1024, v4
  v_subrev_u32 v5, 1024, v5
  v_subrev_u32 v13, 1024, v13
  v_subrev_u32 v14, 1024, v14
  s_cbranch_scc1 F_c1
  s_lshl_b32 s30, s16, 1
  s_sub_u32 s30, 7, s30
F_c2:
  s_sub_u32 s30, s30, 1
  s_cmp_lg_u32 s30, 0
  ds_read_b64_tr_b16 v[40:41], v6 offset:288
  ds_read_b64_tr_b16 v[42:43], v6 offset:256
  ds_read_b128 v[44:47], v4 offset:768
  s_waitcnt lgkmcnt(6)
  v_mfma_f32_32x32x16_bf16 v[64:79], v[20:23], v[16:19], v[64:79]
  ds_read_b64_tr_b16 v[52:53], v6 offset:416
  ds_read_b64_tr_b16 v[54:55], v6 offset:384
  ds_read_b128 v[56:59], v13 offset:512
  s_waitcnt lgkmcnt(6)
  v_mfma_f32_32x32x16_bf16 v[64:79], v[32:35], v[28:31], v[64:79]
  ds_read_b64_tr_b16 v[16:17], v6 offset:544
  ds_read_b64_tr_b16 v[18:19], v6 offset:512
  ds_read_b128 v[20:23], v4 offset:256
  s_waitcnt lgkmcnt(6)
  v_mfma_f32_32x32x16_bf16 v[64:79], v[44:47], v[40:43], v[64:79]
  ds_read_b64_tr_b16 v[28:29], v6 offset:672
  ds_read_b64_tr_b16 v[30:31], v6 offset:640
  ds_read_b128 v[32:35], v13 offset:0
  s_waitcnt lgkmcnt(6)
  v_mfma_f32_32x32x16_bf16 v[64:79], v[56:59], v[52:55], v[64:79]
  v_add_u32 v6, 512, v6
  v_subrev_u32 v4, 1024, v4
  v_subrev_u32 v13, 1024, v13
  s_cbranch_scc1 F_c2
  s_nop 6
  s_waitcnt lgkmcnt(0)
  v_add_f32_dpp v21, v83, v86 wave_ror:1 row_mask:0x1 bank_mask:0x1
  v_add_f32_dpp v17, v67, v70 wave_ror:1 row_mask:0x1 bank_mask:0x1
  v_add_f32_dpp v22, v87, v90 wave_ror:1 row_mask:0x1 bank_mask:0x1
  v_add_f32_dpp v18, v71, v74 wave_ror:1 row_mask:0x1 bank_mask:0x1
  v_add_f32_dpp v23, v91, v94 wave_ror:1 row_mask:0x1 bank_mask:0x1
  v_add_f32_dpp v19, v75, v78 wave_ror:1 row_mask:0x1 bank_mask:0x1
  v_add_f32_dpp v20, v83, v82 wave_shr:1 row_mask:0xf bank_mask:0xf bound_ctrl:0
  v_add_f32_dpp v16, v67, v66 wave_shr:1 row_mask:0xf bank_mask:0xf bound_ctrl:0
  v_add_f32_dpp v21, v87, v86 wave_shr:1 row_mask:0xf bank_mask:0xf
  v_add_f32_dpp v17, v71, v70 wave_shr:1 row_mask:0xf bank_mask:0xf
  v_add_f32_dpp v22, v91, v90 wave_shr:1 row_mask:0xf bank_mask:0xf
  v_add_f32_dpp v18, v75, v74 wave_shr:1 row_mask:0xf bank_mask:0xf
  v_add_f32_dpp v23, v95, v94 wave_shr:1 row_mask:0xf bank_mask:0xf
  v_add_f32_dpp v19, v79, v78 wave_shr:1 row_mask:0xf bank_mask:0xf
  v_add_f32_dpp v86, v20, v85 wave_ror:1 row_mask:0x1 bank_mask:0x1
  v_add_f32_dpp v70, v16, v69 wave_ror:1 row_mask:0x1 bank_mask:0x1
  v_add_f32_dpp v90, v21, v89 wave_ror:1 row_mask:0x1 bank_mask:0x1
  v_add_f32_dpp v74, v17, v73 wave_ror:1 row_mask:0x1 bank_mask:0x1
  v_add_f32_dpp v94, v22, v93 wave_ror:1 row_mask:0x1 bank_mask:0x1
  v_add_f32_dpp v78, v18, v77 wave_ror:1 row_mask:0x1 bank_mask:0x1
  v_add_f32_dpp v82, v20, v81 wave_shr:1 row_mask:0xf bank_mask:0xf bound_ctrl:0
  v_add_f32_dpp v66, v16, v65 wave_shr:1 row_mask:0xf bank_mask:0xf bound_ctrl:0
  v_add_f32_dpp v86, v21, v85 wave_shr:1 row_mask:0xf bank_mask:0xf
  v_add_f32_dpp v70, v17, v69 wave_shr:1 row_mask:0xf bank_mask:0xf
  v_add_f32_dpp v90, v22, v89 wave_shr:1 row_mask:0xf bank_mask:0xf
  v_add_f32_dpp v74, v18, v73 wave_shr:1 row_mask:0xf bank_mask:0xf
  v_add_f32_dpp v94, v23, v93 wave_shr:1 row_mask:0xf bank_mask:0xf
  v_add_f32_dpp v78, v19, v77 wave_shr:1 row_mask:0xf bank_mask:0xf
  v_add_f32_dpp v85, v82, v84 wave_ror:1 row_mask:0x1 bank_mask:0x1
  v_add_f32_dpp v69, v66, v68 wave_ror:1 row_mask:0x1 bank_mask:0x1
  v_add_f32_dpp v89, v86, v88 wave_ror:1 row_mask:0x1 bank_mask:0x1
  v_add_f32_dpp v73, v70, v72 wave_ror:1 row_mask:0x1 bank_mask:0x1
  v_add_f32_dpp v93, v90, v92 wave_ror:1 row_mask:0x1 bank_mask:0x1
  v_add_f32_dpp v77, v74, v76 wave_ror:1 row_mask:0x1 bank_mask:0x1
  v_add_f32_dpp v81, v82, v80 wave_shr:1 row_mask:0xf bank_mask:0xf bound_ctrl:0
  v_add_f32_dpp v65, v66, v64 wave_shr:1 row_mask:0xf bank_mask:0xf bound_ctrl:0
  v_add_f32_dpp v85, v86, v84 wave_shr:1 row_mask:0xf bank_mask:0xf
  v_add_f32_dpp v69, v70, v68 wave_shr:1 row_mask:0xf bank_mask:0xf
  v_add_f32_dpp v89, v90, v88 wave_shr:1 row_mask:0xf bank_mask:0xf
  v_add_f32_dpp v73, v74, v72 wave_shr:1 row_mask:0xf bank_mask:0xf
  v_add_f32_dpp v93, v94, v92 wave_shr:1 row_mask:0xf bank_mask:0xf
  v_add_f32_dpp v77, v78, v76 wave_shr:1 row_mask:0xf bank_mask:0xf
  v_mov_b32 v52, v78
  v_mov_b32 v53, v19
  v_mov_b32 v54, v79
  v_mov_b32 v56, v94
  v_mov_b32 v57, v23
  v_mov_b32 v58, v95
  v_cvt_pk_bf16_f32 v48, v65, v69
  v_cvt_pk_bf16_f32 v49, v73, v77
  v_cvt_pk_bf16_f32 v50, v81, v85
  v_cvt_pk_bf16_f32 v51, v89, v93
  v_lshlrev_b32 v7, 3, v1
  s_lshl1_add_u32 s20, s2, s17
  s_lshl_b32 s18, s20, 12
  s_add_u32 s18, s18, 0x805000
  s_lshl_b32 s22, s16, 9
  s_add_u32 s19, s18, s22
  s_add_u32 s18, s18, 3584
  s_sub_u32 s18, s18, s22
  s_lshl_b32 s20, s20, 7
  s_add_u32 s20, s20, 0xb16000
  s_lshl_b32 s22, s16, 4
  s_add_u32 s21, s20, s22
  s_add_u32 s20, s20, 112
  s_sub_u32 s20, s20, s22
  s_lshl_b32 s38, s90, 12
  s_add_u32 s38, s38, 66560
  v_add_u32 v10, s38, v3
  s_lshl_b32 s38, s90, 9
  s_add_u32 s38, s38, 160512
  v_lshl_add_u32 v5, v1, 2, s38
  s_lshl_b32 s38, s90, 2
  v_mov_b32 v13, s38
  s_lshl2_add_u32 s40, s89, s90
  s_lshl_b32 s40, s40, 10
  s_add_u32 s40, s40, 0xa0600c
  s_mov_b32 s42, 0x17800000
  s_mov_b32 s43, 0x50000000
  s_lshl_b32 s36, s90, 11
  v_add_u32 v6, s36, v3
  s_lshl_b32 s36, s91, 4
  v_mov_b32 v4, s36
  s_setprio 1
  s_mov_b32 s37, 0
MW35:
  ds_read_b128 v[60:63], v4 offset:384
  s_waitcnt lgkmcnt(0)
  v_min3_u32 v60, v60, v61, v62
  v_min_u32 v60, v60, v63
  s_add_u32 s37, s37, 1
  v_readfirstlane_b32 s36, v60
  s_nop 0
  s_cmp_lg_u32 s36, 0
  s_cbranch_scc1 MD36
  s_cmp_lt_u32 s37, 0x186a00
  s_cbranch_scc1 MW35
MD36:
  ds_read_b128 v[64:67], v6 offset:19200
  ds_read_b128 v[72:75], v0
  ds_read_b128 v[68:71], v6 offset:20224
  ds_read_b128 v[76:79], v11
  s_mov_b32 s36, 0
  s_mov_b32 s37, 0
  s_waitcnt lgkmcnt(2)
  v_mfma_f32_32x32x16_bf16 v[16:31], v[72:75], v[64:67], 0
  s_cmp_lg_u32 s36, 0
  s_nop 7
  s_nop 1
  s_waitcnt lgkmcnt(0)
  v_exp_f32 v16, v16
  v_exp_f32 v17, v17
  s_branch F_al1
.p2align 3
F_al:
  s_sub_u32 s36, s36, 1
  s_cmp_lg_u32 s36, 0
  v_exp_f32 v16, v16
  v_exp_f32 v17, v17
  v_smfmac_f32_32x32x32_bf16 v[112:127], v[92:95], v[40:47], v2
F_al1:
  ds_read_b128 v[80:83], v12 offset:0
  ds_read_b128 v[84:87], v0 offset:2080
  v_exp_f32 v18, v18
  v_exp_f32 v19, v19
  v_exp_f32 v20, v20
  v_exp_f32 v21, v21
  v_mfma_f32_32x32x16_bf16 v[32:47], v[72:75], v[68:71], 0
  ds_read_b128 v[88:91], v11 offset:2080
  v_exp_f32 v22, v22
  v_exp_f32 v23, v23
  v_exp_f32 v24, v24
  v_exp_f32 v25, v25
  v_exp_f32 v26, v26
  v_exp_f32 v27, v27
  v_smfmac_f32_32x32x32_bf16 v[96:111], v[76:79], v[16:23], v2
  v_exp_f32 v28, v28
  v_exp_f32 v29, v29
  v_exp_f32 v30, v30
  v_exp_f32 v31, v31
  s_waitcnt lgkmcnt(0)
  v_exp_f32 v32, v32
  v_smfmac_f32_32x32x32_bf16 v[96:111], v[80:83], v[24:31], v2
  v_exp_f32 v33, v33
  v_exp_f32 v34, v34
  v_exp_f32 v35, v35
  v_exp_f32 v36, v36
  v_mfma_f32_32x32x16_bf16 v[16:31], v[84:87], v[64:67], 0
  v_exp_f32 v37, v37
  v_exp_f32 v38, v38
  v_exp_f32 v39, v39
  v_exp_f32 v40, v40
  v_exp_f32 v41, v41
  v_exp_f32 v42, v42
  v_smfmac_f32_32x32x32_bf16 v[112:127], v[76:79], v[32:39], v2
  v_exp_f32_e64 v43, v43
  v_exp_f32 v44, v44
  v_exp_f32 v45, v45
  v_exp_f32 v46, v46
  v_exp_f32 v47, v47
  v_exp_f32 v16, v16
  v_exp_f32 v17, v17
  v_smfmac_f32_32x32x32_bf16 v[112:127], v[80:83], v[40:47], v2
  ds_read_b128 v[92:95], v12 offset:2080
  ds_read_b128 v[72:75], v0 offset:4160
  v_exp_f32 v18, v18
  v_exp_f32 v19, v19
  v_exp_f32 v20, v20
  v_exp_f32 v21, v21
  v_mfma_f32_32x32x16_bf16 v[32:47], v[84:87], v[68:71], 0
  ds_read_b128 v[76:79], v11 offset:4160
  v_exp_f32 v22, v22
  v_exp_f32 v23, v23
  v_exp_f32 v24, v24
  v_exp_f32 v25, v25
  v_exp_f32 v26, v26
  v_exp_f32 v27, v27
  v_smfmac_f32_32x32x32_bf16 v[96:111], v[88:91], v[16:23], v2
  v_exp_f32 v28, v28
  v_exp_f32 v29, v29
  v_exp_f32 v30, v30
  v_exp_f32 v31, v31
  s_waitcnt lgkmcnt(0)
  v_exp_f32 v32, v32
  v_smfmac_f32_32x32x32_bf16 v[96:111], v[92:95], v[24:31], v2
  v_exp_f32 v33, v33
  v_exp_f32 v34, v34
  v_exp_f32 v35, v35
  v_exp_f32 v36, v36
  v_mfma_f32_32x32x16_bf16 v[16:31], v[72:75], v[64:67], 0
  v_exp_f32 v37, v37
  v_exp_f32 v38, v38
  v_exp_f32 v39, v39
  v_exp_f32 v40, v40
  v_exp_f32 v41, v41
  v_exp_f32 v42, v42
  v_smfmac_f32_32x32x32_bf16 v[112:127], v[88:91], v[32:39], v2
  v_exp_f32_e64 v43, v43
  v_exp_f32 v44, v44
  v_exp_f32 v45, v45
  v_exp_f32 v46, v46
  v_exp_f32 v47, v47
  v_exp_f32 v16, v16
  v_exp_f32 v17, v17
  v_smfmac_f32_32x32x32_bf16 v[112:127], v[92:95], v[40:47], v2
  ds_read_b128 v[80:83], v12 offset:4160
  ds_read_b128 v[84:87], v0 offset:6240
  v_exp_f32 v18, v18
  v_exp_f32 v19, v19
  v_exp_f32 v20, v20
  v_exp_f32 v21, v21
  v_mfma_f32_32x32x16_bf16 v[32:47], v[72:75], v[68:71], 0
  ds_read_b128 v[88:91], v11 offset:6240
  v_exp_f32 v22, v22
  v_exp_f32 v23, v23
  v_exp_f32 v24, v24
  v_exp_f32 v25, v25
  v_exp_f32 v26, v26
  v_exp_f32 v27, v27
  v_smfmac_f32_32x32x32_bf16 v[96:111], v[76:79], v[16:23], v2
  v_exp_f32 v28, v28
  v_exp_f32 v29, v29
  v_exp_f32 v30, v30
  v_exp_f32 v31, v31
  s_waitcnt lgkmcnt(0)
  v_exp_f32 v32, v32
  v_smfmac_f32_32x32x32_bf16 v[96:111], v[80:83], v[24:31], v2
  v_exp_f32 v33, v33
  v_exp_f32 v34, v34
  v_exp_f32 v35, v35
  v_exp_f32 v36, v36
  v_mfma_f32_32x32x16_bf16 v[16:31], v[84:87], v[64:67], 0
  v_exp_f32 v37, v37
  v_exp_f32 v38, v38
  v_exp_f32 v39, v39
  v_exp_f32 v40, v40
  v_exp_f32 v41, v41
  v_exp_f32 v42, v42
  v_smfmac_f32_32x32x32_bf16 v[112:127], v[76:79], v[32:39], v2
  v_exp_f32_e64 v43, v43
  v_exp_f32 v44, v44
  v_exp_f32 v45, v45
  v_exp_f32 v46, v46
  v_exp_f32 v47, v47
  v_exp_f32 v16, v16
  v_exp_f32 v17, v17
  v_smfmac_f32_32x32x32_bf16 v[112:127], v[80:83], v[40:47], v2
  ds_read_b128 v[92:95], v12 offset:6240
  ds_read_b128 v[72:75], v0 offset:8320
  v_exp_f32 v18, v18
  v_exp_f32 v19, v19
  v_exp_f32 v20, v20
  v_exp_f32 v21, v21
  v_mfma_f32_32x32x16_bf16 v[32:47], v[84:87], v[68:71], 0
  ds_read_b128 v[76:79], v11 offset:8320
  v_add_u32 v0, 8320, v0
  v_add_u32 v11, 8320, v11
  v_add_u32 v12, 8320, v12
  v_exp_f32 v22, v22
  v_exp_f32 v23, v23
  v_exp_f32 v24, v24
  v_exp_f32 v25, v25
  v_exp_f32 v26, v26
  v_exp_f32 v27, v27
  v_smfmac_f32_32x32x32_bf16 v[96:111], v[88:91], v[16:23], v2
  v_exp_f32 v28, v28
  v_exp_f32 v29, v29
  v_exp_f32 v30, v30
  v_exp_f32 v31, v31
  s_waitcnt lgkmcnt(0)
  v_exp_f32 v32, v32
  v_smfmac_f32_32x32x32_bf16 v[96:111], v[92:95], v[24:31], v2
  v_exp_f32 v33, v33
  v_exp_f32 v34, v34
  v_exp_f32 v35, v35
  v_exp_f32 v36, v36
  v_mfma_f32_32x32x16_bf16 v[16:31], v[72:75], v[64:67], 0
  v_exp_f32 v37, v37
  v_exp_f32 v38, v38
  v_exp_f32 v39, v39
  v_exp_f32 v40, v40
  v_exp_f32 v41, v41
  v_exp_f32 v42, v42
  v_smfmac_f32_32x32x32_bf16 v[112:127], v[88:91], v[32:39], v2
  v_exp_f32_e64 v43, v43
  v_exp_f32 v44, v44
  v_exp_f32 v45, v45
  v_exp_f32 v46, v46
  v_exp_f32 v47, v47
  s_cbranch_scc1 F_al
  s_add_u32 s37, s37, 1
  s_cmp_eq_u32 s37, 4
  s_cbranch_scc1 F_aend
  s_cmp_eq_u32 s37, 1
  s_cbranch_scc0 F_ev2
  ds_read_b128 v[60:63], v8 offset:432
  buffer_store_dwordx2 v[48:49], v7, s[24:27], s18 offen sc1
  buffer_store_dwordx2 v[50:51], v7, s[24:27], s19 offen sc1
  s_mov_b32 exec_lo, 0
  s_mov_b32 exec_hi, 0x80000000
  buffer_store_dwordx4 v[52:55], v8, s[24:27], s20 offen sc1
  buffer_store_dwordx4 v[56:59], v8, s[24:27], s21 offen sc1
  s_mov_b64 exec, -1
  s_cmp_eq_u32 s91, 0
  s_cbranch_scc1 F_ev1
  s_waitcnt vmcnt(0)
  s_mov_b64 exec, 1
  ds_add_u32 v8, v9 offset:56
  s_mov_b64 exec, -1
F_ev1:
  s_waitcnt lgkmcnt(0)
  v_min3_u32 v60, v60, v61, v62
  v_min_u32 v60, v60, v63
  s_mov_b32 s36, 6
  v_readfirstlane_b32 s38, v60
  s_mov_b32 s37, 2
  s_cmp_lg_u32 s38, 0
  s_cbranch_scc1 F_al
  s_mov_b32 s39, 0
MW37:
  ds_read_b128 v[60:63], v8 offset:416
  s_waitcnt lgkmcnt(0)
  v_min3_u32 v60, v60, v61, v62
  v_min_u32 v60, v60, v63
  s_add_u32 s39, s39, 1
  v_readfirstlane_b32 s38, v60
  s_nop 0
  s_cmp_lg_u32 s38, 0
  s_cbranch_scc1 MD38
  s_sleep 1
  s_cmp_lt_u32 s39, 0x186a00
  s_cbranch_scc1 MW37
MD38:
  s_mov_b32 s36, 4
  s_mov_b32 s37, 1
  s_branch F_al
F_ev2:
  s_cmp_eq_u32 s37, 2
  s_cbranch_scc0 F_ev3
  s_mov_b32 s39, 0
MW39:
  ds_read_b128 v[60:63], v8 offset:432
  s_waitcnt lgkmcnt(0)
  v_min3_u32 v60, v60, v61, v62
  v_min_u32 v60, v60, v63
  s_add_u32 s39, s39, 1
  v_readfirstlane_b32 s38, v60
  s_nop 0
  s_cmp_lg_u32 s38, 0
  s_cbranch_scc1 MD40
  s_sleep 1
  s_cmp_lt_u32 s39, 0x186a00
  s_cbranch_scc1 MW39
MD40:
  s_mov_b32 s36, 2
  s_branch F_al
F_ev3:
  s_setprio 0
  s_mov_b32 s36, 1
  s_cmp_eq_u32 s91, 0
  s_cbranch_scc0 F_al
  s_waitcnt vmcnt(0)
  s_mov_b64 exec, 1
  ds_add_u32 v8, v9 offset:20
  s_mov_b64 exec, -1
  s_branch F_al
F_x0:
  s_mov_b32 s39, 0
LW41:
  ds_read_b32 v6, v8 offset:20
  s_waitcnt lgkmcnt(0)
  v_readfirstlane_b32 s38, v6
  s_add_u32 s39, s39, 1
  s_cmp_ge_u32 s38, 4
  s_cbranch_scc1 LD42
  s_sleep 1
  s_cmp_lt_u32 s39, 0x186a00
  s_cbranch_scc1 LW41
LD42:
  ds_write_b128 v10, v[96:99]
  ds_write_b128 v10, v[100:103] offset:1024
  s_nop 1
  ds_write_b128 v10, v[112:115] offset:2048
  ds_write_b128 v10, v[116:119] offset:3072
  ds_write2st64_b32 v5, v104, v120 offset0:0 offset1:1
  s_mov_b64 exec, 1
  ds_add_u32 v13, v9 offset:32
  s_mov_b64 exec, -1
  s_waitcnt lgkmcnt(0)
  s_endpgm
F_aend:
  v_smfmac_f32_32x32x32_bf16 v[112:127], v[92:95], v[40:47], v2
  s_cmp_eq_u32 s91, 0
  s_cbranch_scc1 F_x0
F_mg:
  ds_read_b32 v14, v13 offset:32
  ds_read2st64_b32 v[6:7], v5 offset0:0 offset1:1
  ds_read_b128 v[48:51], v10 offset:0
  ds_read_b128 v[52:55], v10 offset:1024
  ds_read_b128 v[56:59], v10 offset:2048
  ds_read_b128 v[60:63], v10 offset:3072
  s_add_u32 s36, s36, 1
  s_waitcnt lgkmcnt(2)
  v_readfirstlane_b32 s41, v14
  s_cmp_lt_u32 s36, 0x186a00
  s_cselect_b32 s41, s41, 1
  s_cmp_eq_u32 s41, 0
  s_cbranch_scc1 F_mg
  v_add_f32 v104, v104, v6
  v_add_f32 v120, v120, v7
  v_rcp_f32 v6, v104
  v_rcp_f32 v14, v120
  v_add_f32 v96, v96, v48
  v_add_f32 v97, v97, v49
  v_add_f32 v98, v98, v50
  v_add_f32 v99, v99, v51
  v_add_f32 v100, v100, v52
  v_add_f32 v101, v101, v53
  v_add_f32 v102, v102, v54
  v_add_f32 v103, v103, v55
  v_mul_f32 v96, v96, v6
  v_mul_f32 v97, v97, v6
  v_mul_f32 v98, v98, v6
  v_mul_f32 v99, v99, v6
  v_mul_f32 v100, v100, v6
  v_mul_f32 v101, v101, v6
  v_mul_f32 v102, v102, v6
  v_mul_f32 v103, v103, v6
  v_cvt_pk_bf16_f32 v32, v96, v97
  v_cvt_pk_bf16_f32 v33, v98, v99
  v_cvt_pk_bf16_f32 v34, v100, v101
  v_cvt_pk_bf16_f32 v35, v102, v103
  buffer_store_dwordx4 v[32:35], v3, s[24:27], s92 offen sc1
  s_waitcnt lgkmcnt(0)
  v_add_f32 v112, v112, v56
  v_add_f32 v113, v113, v57
  v_add_f32 v114, v114, v58
  v_add_f32 v115, v115, v59
  v_add_f32 v116, v116, v60
  v_add_f32 v117, v117, v61
  v_add_f32 v118, v118, v62
  v_add_f32 v119, v119, v63
  v_mul_f32 v112, v112, v14
  v_mul_f32 v113, v113, v14
  v_mul_f32 v114, v114, v14
  v_mul_f32 v115, v115, v14
  v_mul_f32 v116, v116, v14
  v_mul_f32 v117, v117, v14
  v_mul_f32 v118, v118, v14
  v_mul_f32 v119, v119, v14
  v_cvt_pk_bf16_f32 v36, v112, v113
  v_cvt_pk_bf16_f32 v37, v114, v115
  v_cvt_pk_bf16_f32 v38, v116, v117
  v_cvt_pk_bf16_f32 v39, v118, v119
  buffer_store_dwordx4 v[36:39], v3, s[24:27], s92 offen offset:1024 sc1
  v_fma_f32 v104, v96, 0, v104
  v_fma_f32 v120, v112, 0, v120
  v_fma_f32 v104, v97, 0, v104
  v_fma_f32 v120, v113, 0, v120
  v_fma_f32 v104, v98, 0, v104
  v_fma_f32 v120, v114, 0, v120
  v_fma_f32 v104, v99, 0, v104
  v_fma_f32 v120, v115, 0, v120
  v_fma_f32 v104, v100, 0, v104
  v_fma_f32 v120, v116, 0, v120
  v_fma_f32 v104, v101, 0, v104
  v_fma_f32 v120, v117, 0, v120
  v_fma_f32 v104, v102, 0, v104
  v_fma_f32 v120, v118, 0, v120
  v_fma_f32 v104, v103, 0, v104
  v_fma_f32 v120, v119, 0, v120
  v_subrev_u32 v7, s42, v104
  v_subrev_u32 v6, s42, v120
  v_max_u32 v7, v7, v6
  v_cmp_gt_u32 vcc, s43, v7
  s_nop 0
  s_cmp_eq_u64 vcc, -1
  s_cbranch_scc0 F_slow
F_pub:
  v_lshlrev_b32 v7, 7, v1
  v_lshlrev_b32 v6, s88, v9
  s_waitcnt vmcnt(0)
  s_mov_b64 exec, 0xff
  buffer_atomic_or v6, v7, s[24:27], s40 offen sc1
  s_mov_b64 exec, -1
  s_barrier
  s_endpgm
F_slow:
  s_mov_b32 s37, 2
F_slow0:
  s_lshl_b32 s35, s88, 12
  s_add_u32 s35, s35, 0x202000
  v_mov_b32 v6, 0xff800000
  s_mov_b32 s36, s35
  s_mov_b32 s41, 64
F_slow1:
  buffer_load_dwordx4 v[72:75], v3, s[24:27], s36 offen sc1
  s_bitcmp1_b32 s41, 0
  s_cselect_b32 s38, 0x1f000, 0
  s_add_u32 s36, s36, s38
  s_add_u32 s36, s36, 2048
  s_waitcnt vmcnt(0)
  v_mfma_f32_32x32x16_bf16 v[16:31], v[72:75], v[64:67], 0
  s_nop 7
  s_nop 3
  v_max3_f32 v6, v6, v16, v17
  v_max3_f32 v6, v6, v18, v19
  v_max3_f32 v6, v6, v20, v21
  v_max3_f32 v6, v6, v22, v23
  v_max3_f32 v6, v6, v24, v25
  v_max3_f32 v6, v6, v26, v27
  v_max3_f32 v6, v6, v28, v29
  v_max3_f32 v6, v6, v30, v31
  s_sub_u32 s41, s41, 1
  s_cmp_lg_u32 s41, 0
  s_cbranch_scc1 F_slow1
  v_mov_b32 v13, v6
  s_nop 1
  v_permlane32_swap_b32 v6, v13
  s_nop 1
  v_max_f32 v14, v6, v13
  v_mov_b32 v96, 0
  v_mov_b32 v97, 0
  v_mov_b32 v98, 0
  v_mov_b32 v99, 0
  v_mov_b32 v100, 0
  v_mov_b32 v101, 0
  v_mov_b32 v102, 0
  v_mov_b32 v103, 0
  v_mov_b32 v104, 0
  v_mov_b32 v105, 0
  v_mov_b32 v106, 0
  v_mov_b32 v107, 0
  v_mov_b32 v108, 0
  v_mov_b32 v109, 0
  v_mov_b32 v110, 0
  v_mov_b32 v111, 0
  v_mov_b32 v76, 0x3f803f80
  v_mov_b32 v77, 0x3f803f80
  v_mov_b32 v78, 0x3f803f80
  v_mov_b32 v79, 0x3f803f80
  v_mov_b32 v80, 0x3f803f80
  v_mov_b32 v81, 0x3f803f80
  v_mov_b32 v82, 0x3f803f80
  v_mov_b32 v83, 0x3f803f80
  v_and_b32 v10, 15, v1
  v_lshrrev_b32 v5, 5, v1
  v_lshlrev_b32 v5, 8, v5
  v_lshl_add_u32 v10, v10, 4, v5
  s_mov_b32 s41, 64
F_slow2:
  buffer_load_dwordx4 v[72:75], v3, s[24:27], s35 offen sc1
  s_mov_b32 exec_lo, 0xffff
  s_mov_b32 exec_hi, 0xffff
  buffer_load_dwordx4 v[76:79], v10, s[24:27], s35 offen offset:1024 sc1
  buffer_load_dwordx4 v[80:83], v10, s[24:27], s35 offen offset:1536 sc1
  s_mov_b64 exec, -1
  s_bitcmp1_b32 s41, 0
  s_cselect_b32 s38, 0x1f000, 0
  s_add_u32 s35, s35, s38
  s_add_u32 s35, s35, 2048
  s_waitcnt vmcnt(0)
  v_mfma_f32_32x32x16_bf16 v[16:31], v[72:75], v[64:67], 0
  s_nop 7
  s_nop 3
  v_sub_f32 v16, v16, v14
  v_sub_f32 v17, v17, v14
  v_sub_f32 v18, v18, v14
  v_sub_f32 v19, v19, v14
  v_sub_f32 v20, v20, v14
  v_sub_f32 v21, v21, v14
  v_sub_f32 v22, v22, v14
  v_sub_f32 v23, v23, v14
  v_sub_f32 v24, v24, v14
  v_sub_f32 v25, v25, v14
  v_sub_f32 v26, v26, v14
  v_sub_f32 v27, v27, v14
  v_sub_f32 v28, v28, v14
  v_sub_f32 v29, v29, v14
  v_sub_f32 v30, v30, v14
  v_sub_f32 v31, v31, v14
  v_exp_f32 v16, v16
  v_exp_f32 v17, v17
  v_exp_f32 v18, v18
  v_exp_f32 v19, v19
  v_exp_f32 v20, v20
  v_exp_f32 v21, v21
  v_exp_f32 v22, v22
  v_exp_f32 v23, v23
  v_exp_f32 v24, v24
  v_exp_f32 v25, v25
  v_exp_f32 v26, v26
  v_exp_f32 v27, v27
  v_exp_f32 v28, v28
  v_exp_f32 v29, v29
  v_exp_f32 v30, v30
  v_exp_f32 v31, v31
  s_nop 1
  v_smfmac_f32_32x32x32_bf16 v[96:111], v[76:79], v[16:23], v2
  v_smfmac_f32_32x32x32_bf16 v[96:111], v[80:83], v[24:31], v2
  s_sub_u32 s41, s41, 1
  s_cmp_lg_u32 s41, 0
  s_nop 7
  s_nop 3
  s_cbranch_scc1 F_slow2
  v_rcp_f32 v6, v104
  v_mov_b32 v64, v68
  v_mov_b32 v65, v69
  v_mov_b32 v66, v70
  v_mov_b32 v67, v71
  v_mul_f32 v96, v96, v6
  v_mul_f32 v97, v97, v6
  v_mul_f32 v98, v98, v6
  v_mul_f32 v99, v99, v6
  v_mul_f32 v100, v100, v6
  v_mul_f32 v101, v101, v6
  v_mul_f32 v102, v102, v6
  v_mul_f32 v103, v103, v6
  v_cvt_pk_bf16_f32 v32, v96, v97
  v_cvt_pk_bf16_f32 v33, v98, v99
  v_cvt_pk_bf16_f32 v34, v100, v101
  v_cvt_pk_bf16_f32 v35, v102, v103
  buffer_store_dwordx4 v[32:35], v3, s[24:27], s92 offen sc1
  s_add_u32 s92, s92, 1024
  s_sub_u32 s37, s37, 1
  s_cmp_lg_u32 s37, 0
  s_cbranch_scc1 F_slow0
  s_branch F_pub
F_done:
  s_endpgm
F_codeend:
.fill ((5*4096 + 256 - (F_codeend - F_start)) >> 2), 4, 0xbf810000
.section .rodata,"a"
.p2align 6
.amdhsa_kernel gated_mix__ssm_conv_s4__softmax_full_mha__prompt_kernel
  .amdhsa_next_free_vgpr 128
  .amdhsa_next_free_sgpr 96
  .amdhsa_accum_offset 128
  .amdhsa_group_segment_fixed_size 0
  .amdhsa_kernarg_size 128
  .amdhsa_user_sgpr_count 2
  .amdhsa_user_sgpr_kernarg_segment_ptr 1
  .amdhsa_system_sgpr_workgroup_id_x 1
  .amdhsa_float_denorm_mode_32 3
.end_amdhsa_kernel
```
